```python
import torch

def _softmax(x, axis=-1):
    return torch.softmax(x, dim=axis)
def _gelu(x):
    return torch.nn.functional.gelu(x, approximate="tanh")
def _silu(x):
    return torch.nn.functional.silu(x)
def _sigmoid(x):
    return torch.sigmoid(x)
def _layernorm(x, axis=-1, eps=1e-5):
    m = x.mean(dim=axis, keepdim=True)
    v = x.var(dim=axis, keepdim=True, unbiased=False)
    return (x - m) / torch.sqrt(v + eps)
def _scatter_add(tgt, idx, src, axis=0):
    return tgt.clone().index_add_(axis, idx, src)
def _segment_sum(src, seg, n):
    out = torch.zeros((n,) + src.shape[1:], dtype=src.dtype)
    return out.index_add_(0, seg, src)
def _pad(x, pw):
    flat = tuple(v for pair in reversed(pw) for v in pair)
    return torch.nn.functional.pad(x, flat)

kernel_name = 'sequential_preLN__mha_block_cached__glu_gated_glu__decode'

def setup_inputs():

    _w = (lambda a: (lambda t: t.to(torch.bfloat16) if t.is_floating_point() else t)(torch.as_tensor(a)))
    def _A_setup():
        B, Sq, D = 1, 1, 512
        H, Sk, Dh = 32, 4096, 128
        return {
            "x": _w((lambda *s: torch.randn(*s, dtype=torch.bfloat16) * 0.1)(B, Sq, D)),
            "k_cache": _w((lambda *s: torch.randn(*s, dtype=torch.bfloat16) * 0.8)(B, H, Sk, Dh)),
            "v_cache": _w((lambda *s: torch.randn(*s, dtype=torch.bfloat16) * 1.6)(B, H, Sk, Dh)),
            "wq": _w((lambda *s: torch.randn(*s, dtype=torch.bfloat16) * 0.8)(D, H * Dh) * (D ** -0.5)),
            "wo": _w((lambda *s: torch.randn(*s, dtype=torch.bfloat16) * 1.6)(H * Dh, D) * ((H * Dh) ** -0.5)),
        }
    _A_in = _A_setup()

    def _B_setup():
        B, S, D, F = 1, 1, 512, 1376
        return {
            "x": _w((lambda *s: torch.randn(*s, dtype=torch.bfloat16) * 0.1)(B, S, D)),
            "w_gate": _w((lambda *s: torch.randn(*s, dtype=torch.bfloat16) * 3.2)(D, F)),
            "w_up": _w((lambda *s: torch.randn(*s, dtype=torch.bfloat16) * 0.2)(D, F)),
            "w_down": _w((lambda *s: torch.randn(*s, dtype=torch.bfloat16) * 0.2)(F, D)),
        }
    _B_in = _B_setup()

    return {
        "A_x": _A_in["x"],
        "A_k_cache": _A_in["k_cache"],
        "A_v_cache": _A_in["v_cache"],
        "A_wq": _A_in["wq"],
        "A_wo": _A_in["wo"],
        "B_x": _B_in["x"],
        "B_w_gate": _B_in["w_gate"],
        "B_w_up": _B_in["w_up"],
        "B_w_down": _B_in["w_down"],
    }

def reference(A_x, A_k_cache, A_v_cache, A_wq, A_wo, B_x, B_w_gate, B_w_up, B_w_down):
    def _A_ref(x, k_cache, v_cache, wq, wo):
        B, Sq, D = x.shape
        H, Dh = 32, 128
        q = (lambda x, *d: x.permute(*d))((x @ wq).reshape(B, Sq, H, Dh), 0, 2, 1, 3)
        scores = torch.einsum("bhqd,bhkd->bhqk", q, k_cache) * (Dh ** -0.5)
        p = _softmax(scores, axis=-1)
        o = torch.einsum("bhqk,bhkd->bhqd", p, v_cache)
        return (lambda x, *d: x.permute(*d))(o, 0, 2, 1, 3).reshape(B, Sq, H * Dh) @ wo

    def _B_ref(x, w_gate, w_up, w_down):
        g = torch.einsum("bsd,df->bsf", x, w_gate)
        u = torch.einsum("bsd,df->bsf", x, w_up)
        h = _sigmoid(g) * u
        return torch.einsum("bsf,fd->bsd", h, w_down)

    x = A_x
    h = x + _A_ref(_layernorm(x, axis=-1), A_k_cache, A_v_cache, A_wq, A_wo)
    h2 = h + _B_ref(_layernorm(h, axis=-1), B_w_gate, B_w_up, B_w_down)
    return h2
```

```asm
; @launch grid=(256,1,1) block=(768,1,1) lds=75776
.amdgcn_target "amdgcn-amd-amdhsa--gfx950"
.text
.globl sequential_preLN__mha_block_cached__glu_gated_glu__decode_kernel
.p2align 8
.type sequential_preLN__mha_block_cached__glu_gated_glu__decode_kernel,@function
sequential_preLN__mha_block_cached__glu_gated_glu__decode_kernel:
L_start:
    s_load_dwordx16 s[4:19], s[0:1], 0
    s_load_dwordx8 s[20:27], s[0:1], 64
    s_lshr_b32 s56, s2, 8
    s_cbranch_scc1 L_exit
    s_getpc_b64 s[28:29]
L_pc:
    v_lshlrev_b32 v2, 5, v0
    v_min_u32 v2, L_last-L_pc-4, v2
    global_load_dword v167, v2, s[28:29]
    s_and_b32 s52, s2, 7
    s_lshl_b32 s56, s52, 8
    s_andn2_b32 s57, s2, 7
    s_add_u32 s54, s56, s57
    s_sub_u32 s56, s54, 6
    s_lshl_b32 s56, s56, 14
    v_lshrrev_b32 v1, 6, v0
    v_and_b32 v0, 63, v0
    v_readfirstlane_b32 s3, v1
    v_lshl_add_u32 v1, v1, 14, s56
    v_lshl_add_u32 v1, v0, 4, v1
    s_cmp_lt_u32 s3, 6
    s_cbranch_scc1 L_late
    s_waitcnt lgkmcnt(0)
    global_load_dwordx4 v[40:43], v1, s[6:7] offset:0 nt
    global_load_dwordx4 v[44:47], v1, s[6:7] offset:1024 nt
    global_load_dwordx4 v[48:51], v1, s[6:7] offset:2048 nt
    global_load_dwordx4 v[52:55], v1, s[6:7] offset:3072 nt
L_late:
    s_lshr_b32 s53, s2, 3
    s_lshr_b32 s54, s54, 3
    v_lshlrev_b32 v8, 4, v0
    s_cmp_lg_u32 s3, 0
    s_cbranch_scc1 L_not0
    s_and_b32 s56, s53, 7
    s_lshl_b32 s56, s56, 6
    v_lshrrev_b32 v2, 4, v0
    v_lshl_add_u32 v2, v2, 4, s56
    v_lshlrev_b32 v3, 1, v2
    s_lshr_b32 s56, s54, 3
    s_lshl_b32 s56, s56, 8
    v_lshlrev_b32 v2, 13, v2
    v_and_b32 v9, 15, v0
    v_lshl_add_u32 v2, v9, 4, v2
    v_add_u32 v2, s56, v2
    s_movk_i32 s56, 0x2000
    s_waitcnt lgkmcnt(0)
    global_load_dwordx4 v[104:107], v8, s[4:5]
    global_load_dwordx4 v[12:15], v3, s[4:5]
    global_load_dwordx4 v[16:19], v3, s[4:5] offset:16
    global_load_dwordx4 v[40:43], v2, s[10:11] nt
    v_add_u32 v2, s56, v2
    global_load_dwordx4 v[44:47], v2, s[10:11] nt
    v_add_u32 v2, s56, v2
    global_load_dwordx4 v[48:51], v2, s[10:11] nt
    v_add_u32 v2, s56, v2
    global_load_dwordx4 v[52:55], v2, s[10:11] nt
    v_add_u32 v2, s56, v2
    global_load_dwordx4 v[56:59], v2, s[10:11] nt
    v_add_u32 v2, s56, v2
    global_load_dwordx4 v[60:63], v2, s[10:11] nt
    v_add_u32 v2, s56, v2
    global_load_dwordx4 v[64:67], v2, s[10:11] nt
    v_add_u32 v2, s56, v2
    global_load_dwordx4 v[68:71], v2, s[10:11] nt
    v_add_u32 v2, s56, v2
    global_load_dwordx4 v[72:75], v2, s[10:11] nt
    v_add_u32 v2, s56, v2
    global_load_dwordx4 v[76:79], v2, s[10:11] nt
    v_add_u32 v2, s56, v2
    global_load_dwordx4 v[80:83], v2, s[10:11] nt
    v_add_u32 v2, s56, v2
    global_load_dwordx4 v[84:87], v2, s[10:11] nt
    v_add_u32 v2, s56, v2
    global_load_dwordx4 v[88:91], v2, s[10:11] nt
    v_add_u32 v2, s56, v2
    global_load_dwordx4 v[92:95], v2, s[10:11] nt
    v_add_u32 v2, s56, v2
    global_load_dwordx4 v[96:99], v2, s[10:11] nt
    v_add_u32 v2, s56, v2
    global_load_dwordx4 v[100:103], v2, s[10:11] nt
L_not0:
    s_and_b32 s56, s54, 0xfe
    s_lshl_b32 s56, s56, 1
    s_add_u32 s56, s56, L_table-L_pc
    s_load_dword s75, s[28:29], s56
    s_lshl_b32 s56, s2, 4
    s_add_u32 s56, s56, s3
    s_cmp_eq_u32 s56, 2
    s_cbranch_scc0 L_notlead
    s_waitcnt lgkmcnt(0)
    s_load_dword s56, s[26:27], 0x42000
    s_getreg_b32 s57, hwreg(HW_REG_XCC_ID)
    s_or_b32 s57, s57, 8
    s_lshl_b32 s57, s57, 28
    v_mov_b32 v3, 270336
    v_lshlrev_b32 v4, 6, v0
    s_waitcnt lgkmcnt(0)
    s_add_u32 s56, s56, 0x0e3779b1
    s_and_b32 s56, s56, 0x0fffffff
    s_or_b32 s57, s57, s56
    v_mov_b32 v5, s57
    v_mov_b32 v6, s56
    s_mov_b64 exec, 15
    global_store_dword v4, v5, s[24:25] sc1
    s_mov_b64 exec, 1
    global_store_dword v3, v6, s[26:27] sc1
    s_mov_b64 exec, -1
L_notlead:
    v_mov_b32 v4, 0
    v_mov_b32 v5, 0
    v_mov_b32 v6, 0
    v_mov_b32 v7, 0
    s_mov_b32 s56, 0xff800000
    v_writelane_b32 v4, s56, 0
    ds_write_b128 v8, v[4:7] offset:256
    s_lshl_b32 s56, s3, 9
    v_lshl_add_u32 v9, v0, 3, s56
    ds_write_b64 v9, v[6:7] offset:4096
    s_waitcnt lgkmcnt(0)
    s_bitcmp1_b32 s53, 0
    s_cselect_b32 s77, 16, 0
    s_lshr_b32 s77, s75, s77
    s_and_b32 s41, s77, 3
    s_bfe_u32 s55, s77, 0x70002
    s_bfe_u32 s79, s77, 0x30009
    s_bfe_u32 s78, s77, 0x4000c
    s_add_u32 s40, s79, 6
    s_add_u32 s64, s3, s79
    s_sub_u32 s64, s64, 6
    s_cmp_ge_u32 s3, 6
    s_cbranch_scc1 L_own_unit
    s_add_u32 s78, s78, 5
    s_sub_u32 s78, s78, s3
    s_lshr_b32 s77, s78, 1
    s_mul_i32 s77, s77, 6
    s_add_u32 s77, s77, s78
    s_and_b32 s78, s54, 0xf8
    s_lshl_b32 s78, s78, 3
    s_add_u32 s77, s77, s78
    s_add_u32 s77, s77, 6
    s_lshl_b32 s77, s77, 14
    v_add_u32 v1, s77, v8
L_own_unit:
    s_mov_b32 s67, 0xffff0000
    s_mov_b32 s42, 1023
    v_mov_b32 v33, 256
    v_mov_b32 v39, 1
    s_mov_b32 s28, s6
    s_mov_b32 s29, s7
    s_mov_b32 s30, 0x2000000
    s_mov_b32 s31, 0x20000
    s_mov_b32 s32, s8
    s_mov_b32 s33, s9
    s_mov_b32 s34, 0x2000000
    s_mov_b32 s35, 0x20000
    s_mov_b32 s36, s26
    s_mov_b32 s37, s27
    s_mov_b32 s38, 0x10000000
    s_mov_b32 s39, 0x20000
    s_barrier
    s_cmp_lt_i32 s64, 0
    s_cbranch_scc1 L_helper
    s_mov_b32 s74, 4096
    s_cmp_ge_u32 s3, 6
    s_cbranch_scc1 L_k_rest
    s_mov_b32 s74, 0
    buffer_load_dwordx4 v[40:43], v1, s[28:31], s74 offen nt
    s_addk_i32 s74, 0x400
    buffer_load_dwordx4 v[44:47], v1, s[28:31], s74 offen nt
    s_addk_i32 s74, 0x400
    buffer_load_dwordx4 v[48:51], v1, s[28:31], s74 offen nt
    s_addk_i32 s74, 0x400
    buffer_load_dwordx4 v[52:55], v1, s[28:31], s74 offen nt
    s_addk_i32 s74, 0x400
L_k_rest:
    buffer_load_dwordx4 v[56:59], v1, s[28:31], s74 offen nt
    s_addk_i32 s74, 0x400
    buffer_load_dwordx4 v[60:63], v1, s[28:31], s74 offen nt
    s_addk_i32 s74, 0x400
    buffer_load_dwordx4 v[64:67], v1, s[28:31], s74 offen nt
    s_addk_i32 s74, 0x400
    buffer_load_dwordx4 v[68:71], v1, s[28:31], s74 offen nt
    s_addk_i32 s74, 0x400
    buffer_load_dwordx4 v[72:75], v1, s[28:31], s74 offen nt
    s_addk_i32 s74, 0x400
    buffer_load_dwordx4 v[76:79], v1, s[28:31], s74 offen nt
    s_addk_i32 s74, 0x400
    buffer_load_dwordx4 v[80:83], v1, s[28:31], s74 offen nt
    s_addk_i32 s74, 0x400
    buffer_load_dwordx4 v[84:87], v1, s[28:31], s74 offen nt
    s_addk_i32 s74, 0x400
    buffer_load_dwordx4 v[88:91], v1, s[28:31], s74 offen nt
    s_addk_i32 s74, 0x400
    buffer_load_dwordx4 v[92:95], v1, s[28:31], s74 offen nt
    s_addk_i32 s74, 0x400
    buffer_load_dwordx4 v[96:99], v1, s[28:31], s74 offen nt
    s_addk_i32 s74, 0x400
    buffer_load_dwordx4 v[100:103], v1, s[28:31], s74 offen nt
    s_mov_b32 s74, 0
    buffer_load_dwordx4 v[104:107], v1, s[32:35], s74 offen nt
    s_addk_i32 s74, 0x400
    buffer_load_dwordx4 v[108:111], v1, s[32:35], s74 offen nt
    s_addk_i32 s74, 0x400
    buffer_load_dwordx4 v[112:115], v1, s[32:35], s74 offen nt
    s_addk_i32 s74, 0x400
    buffer_load_dwordx4 v[116:119], v1, s[32:35], s74 offen nt
    s_addk_i32 s74, 0x400
    v_bfe_u32 v10, v0, 3, 1
    v_mul_u32_u24 v10, 0x202, v10
    v_add_u32 v10, 0x100, v10
    v_and_b32 v11, 1, v0
    v_lshlrev_b32 v11, 4, v11
    v_lshlrev_b32 v10, v11, v10
    v_mov_b32 v12, 0x0c0c0000
    v_lshrrev_b32 v12, v11, v12
    v_or_b32 v10, v10, v12
    v_bfe_u32 v11, v0, 1, 2
    v_mov_b32 v12, 0x0c0c0c0c
    v_cmp_eq_u32 vcc, 0, v11
    s_nop 1
    v_cndmask_b32 v6, v12, v10, vcc
    v_cmp_eq_u32 vcc, 1, v11
    s_nop 1
    v_cndmask_b32 v7, v12, v10, vcc
    v_cmp_eq_u32 vcc, 2, v11
    s_nop 1
    v_cndmask_b32 v8, v12, v10, vcc
    v_cmp_eq_u32 vcc, 3, v11
    s_nop 1
    v_cndmask_b32 v9, v12, v10, vcc
    s_mov_b32 s60, 0xcccccccc
    s_mov_b32 s61, 0xcccccccc
    s_mov_b32 s62, 0xaaaaaaaa
    s_mov_b32 s63, 0xaaaaaaaa
    s_mov_b32 s66, 0x3e0293ee
    v_and_b32 v32, 15, v0
    v_lshlrev_b32 v32, 4, v32
    v_lshrrev_b32 v34, 4, v0
    v_and_b32 v35, 7, v0
    v_lshl_add_u32 v34, v34, 3, v35
    s_lshl_b32 s56, s3, 9
    v_lshl_add_u32 v34, v34, 4, s56
    v_lshlrev_b32 v35, 3, v0
    s_lshl_b32 s56, s54, 9
    s_add_u32 s56, s56, 131072
    v_lshl_add_u32 v36, v0, 3, s56
    s_lshl_b32 s56, s54, 4
    s_add_u32 s56, s56, 262144
    v_mov_b32 v37, s56
    s_sub_u32 s43, s40, 1
    v_lshrrev_b32 v26, 1, v32
    v_add_u32 v26, 384, v26
    s_lshl_b32 s56, s3, 3
    s_add_u32 s56, s56, 384
    v_mov_b32 v27, s56
L_spin1:
    ds_read_b32 v10, v33 offset:24
    ds_read_b128 v[2:5], v32 offset:0
    ds_read_b64 v[28:29], v33 offset:48
    s_waitcnt lgkmcnt(0)
    v_readfirstlane_b32 s56, v10
    s_nop 0
    s_cmp_ge_u32 s56, 1
    s_cbranch_scc1 L_spun1
    s_sleep 2
    s_branch L_spin1
L_spun1:
    v_readfirstlane_b32 s59, v28
    v_mov_b32 v38, v29
    s_waitcnt vmcnt(4)
    v_dot2_f32_bf16 v10, v40, v2, 0
    v_dot2_f32_bf16 v11, v44, v2, 0
    v_dot2_f32_bf16 v12, v48, v2, 0
    v_dot2_f32_bf16 v13, v52, v2, 0
    v_dot2_f32_bf16 v14, v56, v2, 0
    v_dot2_f32_bf16 v15, v60, v2, 0
    v_dot2_f32_bf16 v16, v64, v2, 0
    v_dot2_f32_bf16 v17, v68, v2, 0
    v_dot2_f32_bf16 v18, v72, v2, 0
    v_dot2_f32_bf16 v19, v76, v2, 0
    v_dot2_f32_bf16 v20, v80, v2, 0
    v_dot2_f32_bf16 v21, v84, v2, 0
    v_dot2_f32_bf16 v22, v88, v2, 0
    v_dot2_f32_bf16 v23, v92, v2, 0
    v_dot2_f32_bf16 v24, v96, v2, 0
    v_dot2_f32_bf16 v25, v100, v2, 0
    v_dot2_f32_bf16 v10, v41, v3, v10
    v_dot2_f32_bf16 v11, v45, v3, v11
    v_dot2_f32_bf16 v12, v49, v3, v12
    v_dot2_f32_bf16 v13, v53, v3, v13
    v_dot2_f32_bf16 v14, v57, v3, v14
    v_dot2_f32_bf16 v15, v61, v3, v15
    v_dot2_f32_bf16 v16, v65, v3, v16
    v_dot2_f32_bf16 v17, v69, v3, v17
    v_dot2_f32_bf16 v18, v73, v3, v18
    v_dot2_f32_bf16 v19, v77, v3, v19
    v_dot2_f32_bf16 v20, v81, v3, v20
    v_dot2_f32_bf16 v21, v85, v3, v21
    v_dot2_f32_bf16 v22, v89, v3, v22
    v_dot2_f32_bf16 v23, v93, v3, v23
    v_dot2_f32_bf16 v24, v97, v3, v24
    v_dot2_f32_bf16 v25, v101, v3, v25
    v_dot2_f32_bf16 v10, v42, v4, v10
    v_dot2_f32_bf16 v11, v46, v4, v11
    v_dot2_f32_bf16 v12, v50, v4, v12
    v_dot2_f32_bf16 v13, v54, v4, v13
    v_dot2_f32_bf16 v14, v58, v4, v14
    v_dot2_f32_bf16 v15, v62, v4, v15
    v_dot2_f32_bf16 v16, v66, v4, v16
    v_dot2_f32_bf16 v17, v70, v4, v17
    v_dot2_f32_bf16 v18, v74, v4, v18
    v_dot2_f32_bf16 v19, v78, v4, v19
    v_dot2_f32_bf16 v20, v82, v4, v20
    v_dot2_f32_bf16 v21, v86, v4, v21
    v_dot2_f32_bf16 v22, v90, v4, v22
    v_dot2_f32_bf16 v23, v94, v4, v23
    v_dot2_f32_bf16 v24, v98, v4, v24
    v_dot2_f32_bf16 v25, v102, v4, v25
    v_dot2_f32_bf16 v10, v43, v5, v10
    v_dot2_f32_bf16 v11, v47, v5, v11
    v_dot2_f32_bf16 v12, v51, v5, v12
    v_dot2_f32_bf16 v13, v55, v5, v13
    v_dot2_f32_bf16 v14, v59, v5, v14
    v_dot2_f32_bf16 v15, v63, v5, v15
    v_dot2_f32_bf16 v16, v67, v5, v16
    v_dot2_f32_bf16 v17, v71, v5, v17
    v_dot2_f32_bf16 v18, v75, v5, v18
    v_dot2_f32_bf16 v19, v79, v5, v19
    v_dot2_f32_bf16 v20, v83, v5, v20
    v_dot2_f32_bf16 v21, v87, v5, v21
    v_dot2_f32_bf16 v22, v91, v5, v22
    v_dot2_f32_bf16 v23, v95, v5, v23
    v_dot2_f32_bf16 v24, v99, v5, v24
    v_dot2_f32_bf16 v25, v103, v5, v25
    v_add_f32_dpp v10, v10, v10 row_ror:8 row_mask:0xf bank_mask:0x3
    v_add_f32_dpp v10, v18, v18 row_ror:8 row_mask:0xf bank_mask:0xc
    v_add_f32_dpp v11, v11, v11 row_ror:8 row_mask:0xf bank_mask:0x3
    v_add_f32_dpp v11, v19, v19 row_ror:8 row_mask:0xf bank_mask:0xc
    v_add_f32_dpp v12, v12, v12 row_ror:8 row_mask:0xf bank_mask:0x3
    v_add_f32_dpp v12, v20, v20 row_ror:8 row_mask:0xf bank_mask:0xc
    v_add_f32_dpp v13, v13, v13 row_ror:8 row_mask:0xf bank_mask:0x3
    v_add_f32_dpp v13, v21, v21 row_ror:8 row_mask:0xf bank_mask:0xc
    v_add_f32_dpp v14, v14, v14 row_ror:8 row_mask:0xf bank_mask:0x3
    v_add_f32_dpp v14, v22, v22 row_ror:8 row_mask:0xf bank_mask:0xc
    v_add_f32_dpp v15, v15, v15 row_ror:8 row_mask:0xf bank_mask:0x3
    v_add_f32_dpp v15, v23, v23 row_ror:8 row_mask:0xf bank_mask:0xc
    v_add_f32_dpp v16, v16, v16 row_ror:8 row_mask:0xf bank_mask:0x3
    v_add_f32_dpp v16, v24, v24 row_ror:8 row_mask:0xf bank_mask:0xc
    v_add_f32_dpp v17, v17, v17 row_ror:8 row_mask:0xf bank_mask:0x3
    v_add_f32_dpp v17, v25, v25 row_ror:8 row_mask:0xf bank_mask:0xc
    v_add_f32_dpp v10, v10, v10 row_ror:12 row_mask:0xf bank_mask:0x5
    v_add_f32_dpp v10, v14, v14 row_ror:4 row_mask:0xf bank_mask:0xa
    v_add_f32_dpp v11, v11, v11 row_ror:12 row_mask:0xf bank_mask:0x5
    v_add_f32_dpp v11, v15, v15 row_ror:4 row_mask:0xf bank_mask:0xa
    v_add_f32_dpp v12, v12, v12 row_ror:12 row_mask:0xf bank_mask:0x5
    v_add_f32_dpp v12, v16, v16 row_ror:4 row_mask:0xf bank_mask:0xa
    v_add_f32_dpp v13, v13, v13 row_ror:12 row_mask:0xf bank_mask:0x5
    v_add_f32_dpp v13, v17, v17 row_ror:4 row_mask:0xf bank_mask:0xa
    v_add_f32_dpp v10, v10, v10 quad_perm:[2,3,0,1] row_mask:0xf bank_mask:0xf
    v_add_f32_dpp v11, v11, v11 quad_perm:[2,3,0,1] row_mask:0xf bank_mask:0xf
    v_add_f32_dpp v12, v12, v12 quad_perm:[2,3,0,1] row_mask:0xf bank_mask:0xf
    v_add_f32_dpp v13, v13, v13 quad_perm:[2,3,0,1] row_mask:0xf bank_mask:0xf
    v_cndmask_b32 v10, v10, v12, s[60:61]
    v_cndmask_b32 v11, v11, v13, s[60:61]
    s_nop 0
    v_add_f32_dpp v10, v10, v10 quad_perm:[1,0,3,2] row_mask:0xf bank_mask:0xf
    v_add_f32_dpp v11, v11, v11 quad_perm:[1,0,3,2] row_mask:0xf bank_mask:0xf
    v_cndmask_b32 v10, v10, v11, s[62:63]
    v_mul_f32 v10, s66, v10
    s_nop 1
    v_max_f32_dpp v11, v10, v10 row_ror:8 row_mask:0xf bank_mask:0xf
    s_nop 1
    v_max_f32_dpp v11, v11, v11 row_ror:4 row_mask:0xf bank_mask:0xf
    s_nop 1
    v_max_f32_dpp v11, v11, v11 row_ror:2 row_mask:0xf bank_mask:0xf
    s_nop 1
    v_max_f32_dpp v11, v11, v11 row_ror:1 row_mask:0xf bank_mask:0xf
    v_mov_b32 v12, v11
    s_nop 1
    v_permlane16_swap_b32 v11, v12
    v_max_f32 v11, v11, v12
    v_mov_b32 v12, v11
    s_nop 1
    v_permlane32_swap_b32 v11, v12
    v_max_f32 v11, v11, v12
    v_sub_f32 v10, v10, v11
    v_exp_f32 v10, v10
    s_nop 0
    v_cvt_pk_bf16_f32 v13, v10, v10
    v_lshlrev_b32 v13, 16, v13
    v_sub_f32 v13, v10, v13
    v_cvt_pk_bf16_f32 v13, v10, v13
    v_add_f32_dpp v10, v10, v10 row_ror:8 row_mask:0xf bank_mask:0xf
    s_nop 1
    v_add_f32_dpp v10, v10, v10 row_ror:4 row_mask:0xf bank_mask:0xf
    s_nop 1
    v_add_f32_dpp v10, v10, v10 row_ror:2 row_mask:0xf bank_mask:0xf
    s_nop 1
    v_add_f32_dpp v10, v10, v10 row_ror:1 row_mask:0xf bank_mask:0xf
    v_mov_b32 v12, v10
    s_nop 1
    v_permlane16_swap_b32 v10, v12
    v_add_f32 v10, v10, v12
    v_mov_b32 v12, v10
    s_nop 1
    v_permlane32_swap_b32 v10, v12
    v_add_f32 v10, v10, v12
    v_mov_b32 v20, v11
    v_mov_b32 v21, v10
    s_mov_b64 exec, 1
    ds_write_b64 v27, v[20:21]
    ds_max_f32 v33, v11
    ds_add_rtn_u32 v12, v33, v39 offset:28
    s_mov_b64 exec, -1
    ds_read_b64 v[22:23], v26
    ds_read_b32 v20, v33
    s_waitcnt lgkmcnt(0)
    v_readfirstlane_b32 s56, v12
    s_nop 0
    s_cmp_lg_u32 s56, s43
    s_cbranch_scc1 L_kv_nost
    v_bfi_b32 v20, s42, 0, v20
    v_sub_f32 v22, v22, v20
    v_min_f32 v22, 0x42800000, v22
    v_exp_f32 v22, v22
    s_nop 0
    v_mul_f32 v21, v22, v23
    s_nop 1
    v_add_f32_dpp v21, v21, v21 row_ror:8 row_mask:0xf bank_mask:0xf
    s_nop 1
    v_add_f32_dpp v21, v21, v21 row_ror:4 row_mask:0xf bank_mask:0xf
    s_nop 1
    v_add_f32_dpp v21, v21, v21 row_ror:2 row_mask:0xf bank_mask:0xf
    s_nop 1
    v_add_f32_dpp v21, v21, v21 row_ror:1 row_mask:0xf bank_mask:0xf
    v_bfi_b32 v20, s42, v38, v20
    v_bfi_b32 v21, s42, v38, v21
    v_mov_b32 v22, v38
    v_mov_b32 v23, v38
    s_mov_b64 exec, 1
    s_setprio 3
    s_cmp_eq_u32 s59, 0
    s_cbranch_scc1 L_slow2
    buffer_store_dwordx4 v[20:23], v37, s[36:39], 0 offen
    s_branch L_sdone2
L_slow2:
    buffer_store_dwordx4 v[20:23], v37, s[36:39], 0 offen sc1
L_sdone2:
    s_setprio 0
    s_mov_b64 exec, -1
L_kv_nost:
    buffer_load_dwordx4 v[120:123], v1, s[32:35], s74 offen nt
    s_addk_i32 s74, 0x400
    buffer_load_dwordx4 v[124:127], v1, s[32:35], s74 offen nt
    s_addk_i32 s74, 0x400
    buffer_load_dwordx4 v[128:131], v1, s[32:35], s74 offen nt
    s_addk_i32 s74, 0x400
    buffer_load_dwordx4 v[132:135], v1, s[32:35], s74 offen nt
    s_addk_i32 s74, 0x400
    buffer_load_dwordx4 v[136:139], v1, s[32:35], s74 offen nt
    s_addk_i32 s74, 0x400
    buffer_load_dwordx4 v[140:143], v1, s[32:35], s74 offen nt
    s_addk_i32 s74, 0x400
    buffer_load_dwordx4 v[144:147], v1, s[32:35], s74 offen nt
    s_addk_i32 s74, 0x400
    buffer_load_dwordx4 v[148:151], v1, s[32:35], s74 offen nt
    s_addk_i32 s74, 0x400
    buffer_load_dwordx4 v[152:155], v1, s[32:35], s74 offen nt
    s_addk_i32 s74, 0x400
    buffer_load_dwordx4 v[156:159], v1, s[32:35], s74 offen nt
    s_addk_i32 s74, 0x400
    buffer_load_dwordx4 v[160:163], v1, s[32:35], s74 offen nt
    s_addk_i32 s74, 0x400
    buffer_load_dwordx4 v[164:167], v1, s[32:35], s74 offen nt
    s_mov_b32 s74, 0
    v_mov_b32_dpp v14, v13 row_newbcast:0 row_mask:0xf bank_mask:0xf
    v_mov_b32_dpp v15, v13 row_newbcast:1 row_mask:0xf bank_mask:0xf
    v_perm_b32 v40, v14, v14, v6
    v_perm_b32 v41, v14, v14, v7
    v_perm_b32 v42, v14, v14, v8
    v_perm_b32 v43, v14, v14, v9
    v_mov_b32_dpp v16, v13 row_newbcast:2 row_mask:0xf bank_mask:0xf
    v_perm_b32 v44, v15, v15, v6
    v_perm_b32 v45, v15, v15, v7
    v_perm_b32 v46, v15, v15, v8
    v_perm_b32 v47, v15, v15, v9
    v_mov_b32_dpp v17, v13 row_newbcast:3 row_mask:0xf bank_mask:0xf
    v_perm_b32 v48, v16, v16, v6
    v_perm_b32 v49, v16, v16, v7
    v_perm_b32 v50, v16, v16, v8
    v_perm_b32 v51, v16, v16, v9
    v_mov_b32_dpp v14, v13 row_newbcast:4 row_mask:0xf bank_mask:0xf
    v_perm_b32 v52, v17, v17, v6
    v_perm_b32 v53, v17, v17, v7
    v_perm_b32 v54, v17, v17, v8
    v_perm_b32 v55, v17, v17, v9
    v_mov_b32_dpp v15, v13 row_newbcast:5 row_mask:0xf bank_mask:0xf
    v_perm_b32 v56, v14, v14, v6
    v_perm_b32 v57, v14, v14, v7
    v_perm_b32 v58, v14, v14, v8
    v_perm_b32 v59, v14, v14, v9
    v_mov_b32_dpp v16, v13 row_newbcast:6 row_mask:0xf bank_mask:0xf
    v_perm_b32 v60, v15, v15, v6
    v_perm_b32 v61, v15, v15, v7
    v_perm_b32 v62, v15, v15, v8
    v_perm_b32 v63, v15, v15, v9
    v_mov_b32_dpp v17, v13 row_newbcast:7 row_mask:0xf bank_mask:0xf
    v_perm_b32 v64, v16, v16, v6
    v_perm_b32 v65, v16, v16, v7
    v_perm_b32 v66, v16, v16, v8
    v_perm_b32 v67, v16, v16, v9
    v_mov_b32_dpp v14, v13 row_newbcast:8 row_mask:0xf bank_mask:0xf
    v_perm_b32 v68, v17, v17, v6
    v_perm_b32 v69, v17, v17, v7
    v_perm_b32 v70, v17, v17, v8
    v_perm_b32 v71, v17, v17, v9
    v_mov_b32_dpp v15, v13 row_newbcast:9 row_mask:0xf bank_mask:0xf
    v_perm_b32 v72, v14, v14, v6
    v_perm_b32 v73, v14, v14, v7
    v_perm_b32 v74, v14, v14, v8
    v_perm_b32 v75, v14, v14, v9
    v_mov_b32_dpp v16, v13 row_newbcast:10 row_mask:0xf bank_mask:0xf
    v_perm_b32 v76, v15, v15, v6
    v_perm_b32 v77, v15, v15, v7
    v_perm_b32 v78, v15, v15, v8
    v_perm_b32 v79, v15, v15, v9
    v_mov_b32_dpp v17, v13 row_newbcast:11 row_mask:0xf bank_mask:0xf
    v_perm_b32 v80, v16, v16, v6
    v_perm_b32 v81, v16, v16, v7
    v_perm_b32 v82, v16, v16, v8
    v_perm_b32 v83, v16, v16, v9
    v_mov_b32_dpp v14, v13 row_newbcast:12 row_mask:0xf bank_mask:0xf
    v_perm_b32 v84, v17, v17, v6
    v_perm_b32 v85, v17, v17, v7
    v_perm_b32 v86, v17, v17, v8
    v_perm_b32 v87, v17, v17, v9
    v_mov_b32_dpp v15, v13 row_newbcast:13 row_mask:0xf bank_mask:0xf
    v_perm_b32 v88, v14, v14, v6
    v_perm_b32 v89, v14, v14, v7
    v_perm_b32 v90, v14, v14, v8
    v_perm_b32 v91, v14, v14, v9
    v_mov_b32_dpp v16, v13 row_newbcast:14 row_mask:0xf bank_mask:0xf
    v_perm_b32 v92, v15, v15, v6
    v_perm_b32 v93, v15, v15, v7
    v_perm_b32 v94, v15, v15, v8
    v_perm_b32 v95, v15, v15, v9
    v_mov_b32_dpp v17, v13 row_newbcast:15 row_mask:0xf bank_mask:0xf
    v_perm_b32 v96, v16, v16, v6
    v_perm_b32 v97, v16, v16, v7
    v_perm_b32 v98, v16, v16, v8
    v_perm_b32 v99, v16, v16, v9
    v_perm_b32 v100, v17, v17, v6
    v_perm_b32 v101, v17, v17, v7
    v_perm_b32 v102, v17, v17, v8
    v_perm_b32 v103, v17, v17, v9
L_spin3:
    ds_read_b32 v12, v33 offset:28
    ds_read_b32 v19, v33
    s_waitcnt lgkmcnt(0)
    v_readfirstlane_b32 s56, v12
    s_nop 0
    s_cmp_ge_u32 s56, s40
    s_cbranch_scc1 L_spun3
    s_sleep 2
    s_branch L_spin3
L_spun3:
    v_bfi_b32 v19, s42, 0, v19
    v_sub_f32 v18, v11, v19
    v_exp_f32 v18, v18
    s_waitcnt vmcnt(15)
    v_mfma_f32_16x16x32_bf16 v[28:31], v[104:107], v[40:43], 0
    s_waitcnt vmcnt(14)
    v_mfma_f32_16x16x32_bf16 v[28:31], v[108:111], v[44:47], v[28:31]
    s_waitcnt vmcnt(13)
    v_mfma_f32_16x16x32_bf16 v[28:31], v[112:115], v[48:51], v[28:31]
    s_waitcnt vmcnt(12)
    v_mfma_f32_16x16x32_bf16 v[28:31], v[116:119], v[52:55], v[28:31]
    s_waitcnt vmcnt(11)
    v_mfma_f32_16x16x32_bf16 v[28:31], v[120:123], v[56:59], v[28:31]
    s_waitcnt vmcnt(10)
    v_mfma_f32_16x16x32_bf16 v[28:31], v[124:127], v[60:63], v[28:31]
    s_waitcnt vmcnt(9)
    v_mfma_f32_16x16x32_bf16 v[28:31], v[128:131], v[64:67], v[28:31]
    s_waitcnt vmcnt(8)
    v_mfma_f32_16x16x32_bf16 v[28:31], v[132:135], v[68:71], v[28:31]
    s_waitcnt vmcnt(7)
    v_mfma_f32_16x16x32_bf16 v[28:31], v[136:139], v[72:75], v[28:31]
    s_waitcnt vmcnt(6)
    v_mfma_f32_16x16x32_bf16 v[28:31], v[140:143], v[76:79], v[28:31]
    s_waitcnt vmcnt(5)
    v_mfma_f32_16x16x32_bf16 v[28:31], v[144:147], v[80:83], v[28:31]
    s_waitcnt vmcnt(4)
    v_mfma_f32_16x16x32_bf16 v[28:31], v[148:151], v[84:87], v[28:31]
    s_waitcnt vmcnt(3)
    v_mfma_f32_16x16x32_bf16 v[28:31], v[152:155], v[88:91], v[28:31]
    s_waitcnt vmcnt(2)
    v_mfma_f32_16x16x32_bf16 v[28:31], v[156:159], v[92:95], v[28:31]
    s_waitcnt vmcnt(1)
    v_mfma_f32_16x16x32_bf16 v[28:31], v[160:163], v[96:99], v[28:31]
    s_waitcnt vmcnt(0)
    v_mfma_f32_16x16x32_bf16 v[28:31], v[164:167], v[100:103], v[28:31]
    s_nop 7
    v_add_f32_dpp v28, v28, v28 row_ror:8 row_mask:0xf bank_mask:0xf
    v_add_f32_dpp v29, v29, v29 row_ror:8 row_mask:0xf bank_mask:0xf
    v_add_f32_dpp v30, v30, v30 row_ror:8 row_mask:0xf bank_mask:0xf
    v_add_f32_dpp v31, v31, v31 row_ror:8 row_mask:0xf bank_mask:0xf
    v_pk_mul_f32 v[28:29], v[28:29], v[18:19] op_sel_hi:[1,0]
    v_pk_mul_f32 v[30:31], v[30:31], v[18:19] op_sel_hi:[1,0]
    s_mov_b32 exec_lo, 0x00ff00ff
    s_mov_b32 exec_hi, 0x00ff00ff
    ds_write_b128 v34, v[28:31] offset:4096
    s_mov_b64 exec, 1
    ds_add_rtn_u32 v12, v33, v39 offset:36
    s_mov_b64 exec, -1
    ds_read_b64 v[40:41], v35 offset:5120
    ds_read_b64 v[42:43], v35 offset:5632
    ds_read_b64 v[44:45], v35 offset:6144
    ds_read_b64 v[46:47], v35 offset:6656
    ds_read_b64 v[48:49], v35 offset:7168
    ds_read_b64 v[50:51], v35 offset:7680
    ds_read_b64 v[52:53], v35 offset:8192
    ds_read_b64 v[54:55], v35 offset:8704
    ds_read_b64 v[56:57], v35 offset:9216
    ds_read_b64 v[58:59], v35 offset:9728
    s_waitcnt lgkmcnt(6)
    v_readfirstlane_b32 s56, v12
    v_pk_add_f32 v[40:41], v[40:41], v[42:43]
    v_pk_add_f32 v[44:45], v[44:45], v[46:47]
    s_waitcnt lgkmcnt(2)
    v_pk_add_f32 v[48:49], v[48:49], v[50:51]
    v_pk_add_f32 v[52:53], v[52:53], v[54:55]
    v_pk_add_f32 v[40:41], v[40:41], v[44:45]
    s_waitcnt lgkmcnt(0)
    v_pk_add_f32 v[56:57], v[56:57], v[58:59]
    v_pk_add_f32 v[48:49], v[48:49], v[52:53]
    v_pk_add_f32 v[40:41], v[40:41], v[56:57]
    v_pk_add_f32 v[18:19], v[40:41], v[48:49]
    v_bfi_b32 v18, s42, v38, v18
    s_cmp_lg_u32 s56, s43
    s_cbranch_scc1 L_kv_end
    s_cmp_eq_u32 s59, 0
    s_cbranch_scc1 L_slow4
    buffer_store_dwordx2 v[18:19], v36, s[36:39], 0 offen
    s_branch L_sdone4
L_slow4:
    buffer_store_dwordx2 v[18:19], v36, s[36:39], 0 offen sc1
L_sdone4:
    ds_write_b32 v33, v39 offset:32
L_kv_end:
    s_endpgm
L_helper:
    s_mov_b32 s68, 0
    s_mov_b32 s69, 4096
    s_mov_b32 s70, 8192
    s_mov_b32 s71, 12288
    s_mov_b32 s72, 16384
    s_mov_b32 s73, 20480
    s_mov_b32 s48, s4
    s_mov_b32 s49, s5
    s_mov_b32 s50, 0x400
    s_mov_b32 s51, 0x20000
    s_cmp_eq_u32 s3, 0
    s_cbranch_scc1 L_q
    s_cmp_ge_u32 s3, 4
    s_cbranch_scc1 L_idle
    s_lshl_b32 s56, s2, 4
    s_add_u32 s56, s56, s3
    s_cmp_eq_u32 s56, 2
    s_cbranch_scc0 L_roles
    s_load_dword s80, s[26:27], 0x44000 glc
    s_load_dword s81, s[26:27], 0x46000 glc
    s_mov_b32 s82, -1
    s_mov_b32 s83, -1
    s_mov_b32 s77, 5
    s_mov_b32 s78, 0
    s_waitcnt lgkmcnt(0)
L_probe:
    s_not_b32 s56, s80
    s_mov_b32 s57, 0
    s_load_dword s56, s[26:27], 0x44000 glc
L_probe0:
    s_add_u32 s57, s57, 1
    s_cmp_eq_u32 s56, s80
    s_cbranch_scc1 L_probed0
    s_cmp_lt_u32 s57, 0x100
    s_cbranch_scc1 L_probe0
L_probed0:
    s_waitcnt lgkmcnt(0)
    s_min_u32 s82, s82, s57
    s_add_u32 s78, s78, s57
    s_not_b32 s56, s81
    s_mov_b32 s57, 0
    s_load_dword s56, s[26:27], 0x46000 glc
L_probe1:
    s_add_u32 s57, s57, 1
    s_cmp_eq_u32 s56, s81
    s_cbranch_scc1 L_probed1
    s_cmp_lt_u32 s57, 0x100
    s_cbranch_scc1 L_probe1
L_probed1:
    s_waitcnt lgkmcnt(0)
    s_min_u32 s83, s83, s57
    s_add_u32 s78, s78, s57
    s_cmp_lt_u32 s78, 200
    s_cselect_b32 s77, s77, 1
    s_sub_u32 s77, s77, 1
    s_cmp_lg_u32 s77, 0
    s_cbranch_scc1 L_probe
    s_getreg_b32 s56, hwreg(HW_REG_XCC_ID)
    s_bfe_u32 s56, s56, 0x10002
    s_cmp_lt_u32 s83, s82
    s_cselect_b32 s57, 3, 2
    s_xor_b32 s57, s57, s56
    v_mov_b32 v4, s57
    v_mov_b32 v3, 4
    s_mov_b64 exec, 1
    global_store_dword v3, v4, s[24:25] sc1
    s_mov_b64 exec, -1
    s_branch L_roles
L_idle:
    s_endpgm
L_q:
    v_and_b32 v28, 1, v0
    v_lshlrev_b32 v28, 4, v28
    v_mov_b32 v29, 0x100
    v_lshlrev_b32 v29, v28, v29
    v_mov_b32 v30, 0x0c0c0000
    v_lshrrev_b32 v30, v28, v30
    v_or_b32 v29, v29, v30
    v_bfe_u32 v28, v0, 1, 3
    v_mov_b32 v30, 0x0c0c0c0c
    v_cmp_eq_u32 vcc, 0, v28
    s_nop 1
    v_cndmask_b32 v20, v30, v29, vcc
    v_cmp_eq_u32 vcc, 1, v28
    s_nop 1
    v_cndmask_b32 v21, v30, v29, vcc
    v_cmp_eq_u32 vcc, 2, v28
    s_nop 1
    v_cndmask_b32 v22, v30, v29, vcc
    v_cmp_eq_u32 vcc, 3, v28
    s_nop 1
    v_cndmask_b32 v23, v30, v29, vcc
    s_waitcnt vmcnt(16)
    v_lshlrev_b32 v112, 16, v104
    v_and_b32 v113, s67, v104
    v_lshlrev_b32 v114, 16, v105
    v_and_b32 v115, s67, v105
    v_lshlrev_b32 v116, 16, v106
    v_and_b32 v117, s67, v106
    v_lshlrev_b32 v118, 16, v107
    v_and_b32 v119, s67, v107
    v_add_f32 v36, v112, v113
    v_add_f32 v37, v114, v115
    v_add_f32 v34, v116, v117
    v_add_f32 v35, v118, v119
    v_add_f32 v36, v36, v37
    v_add_f32 v34, v34, v35
    v_add_f32 v36, v36, v34
    s_nop 1
    v_add_f32_dpp v36, v36, v36 row_ror:8 row_mask:0xf bank_mask:0xf
    s_nop 1
    v_add_f32_dpp v36, v36, v36 row_ror:4 row_mask:0xf bank_mask:0xf
    s_nop 1
    v_add_f32_dpp v36, v36, v36 row_ror:2 row_mask:0xf bank_mask:0xf
    s_nop 1
    v_add_f32_dpp v36, v36, v36 row_ror:1 row_mask:0xf bank_mask:0xf
    v_mov_b32 v37, v36
    s_nop 1
    v_permlane16_swap_b32 v36, v37
    v_add_f32 v36, v36, v37
    v_mov_b32 v37, v36
    s_nop 1
    v_permlane32_swap_b32 v36, v37
    v_add_f32 v36, v36, v37
    v_mul_f32 v36, 0x3b000000, v36
    v_sub_f32 v112, v112, v36
    v_sub_f32 v113, v113, v36
    v_sub_f32 v114, v114, v36
    v_sub_f32 v115, v115, v36
    v_sub_f32 v116, v116, v36
    v_sub_f32 v117, v117, v36
    v_sub_f32 v118, v118, v36
    v_sub_f32 v119, v119, v36
    v_mul_f32 v37, v112, v112
    v_fmac_f32 v37, v113, v113
    v_fmac_f32 v37, v114, v114
    v_fmac_f32 v37, v115, v115
    v_fmac_f32 v37, v116, v116
    v_fmac_f32 v37, v117, v117
    v_fmac_f32 v37, v118, v118
    v_fmac_f32 v37, v119, v119
    s_nop 1
    v_add_f32_dpp v37, v37, v37 row_ror:8 row_mask:0xf bank_mask:0xf
    s_nop 1
    v_add_f32_dpp v37, v37, v37 row_ror:4 row_mask:0xf bank_mask:0xf
    s_nop 1
    v_add_f32_dpp v37, v37, v37 row_ror:2 row_mask:0xf bank_mask:0xf
    s_nop 1
    v_add_f32_dpp v37, v37, v37 row_ror:1 row_mask:0xf bank_mask:0xf
    v_mov_b32 v34, v37
    s_nop 1
    v_permlane16_swap_b32 v37, v34
    v_add_f32 v37, v37, v34
    v_mov_b32 v34, v37
    s_nop 1
    v_permlane32_swap_b32 v37, v34
    v_add_f32 v37, v37, v34
    v_mul_f32 v37, 0x3b000000, v37
    v_cvt_pk_bf16_f32 v34, v36, v37
    v_lshlrev_b32 v36, 16, v34
    v_and_b32 v37, s67, v34
    v_add_f32 v37, 0x3727c5ac, v37
    v_cvt_pk_bf16_f32 v37, v37, v37
    v_and_b32 v37, s67, v37
    v_sqrt_f32 v37, v37
    s_nop 0
    v_cvt_pk_bf16_f32 v37, v37, v37
    v_and_b32 v37, s67, v37
    v_rcp_f32 v37, v37
    v_lshlrev_b32 v28, 16, v12
    v_and_b32 v29, s67, v12
    v_sub_f32 v28, v28, v36
    v_sub_f32 v29, v29, v36
    v_cvt_pk_bf16_f32 v30, v28, v29
    v_lshlrev_b32 v28, 16, v30
    v_and_b32 v29, s67, v30
    v_mul_f32 v28, v28, v37
    v_mul_f32 v29, v29, v37
    v_cvt_pk_bf16_f32 v12, v28, v29
    v_lshlrev_b32 v28, 16, v13
    v_and_b32 v29, s67, v13
    v_sub_f32 v28, v28, v36
    v_sub_f32 v29, v29, v36
    v_cvt_pk_bf16_f32 v30, v28, v29
    v_lshlrev_b32 v28, 16, v30
    v_and_b32 v29, s67, v30
    v_mul_f32 v28, v28, v37
    v_mul_f32 v29, v29, v37
    v_cvt_pk_bf16_f32 v13, v28, v29
    v_lshlrev_b32 v28, 16, v14
    v_and_b32 v29, s67, v14
    v_sub_f32 v28, v28, v36
    v_sub_f32 v29, v29, v36
    v_cvt_pk_bf16_f32 v30, v28, v29
    v_lshlrev_b32 v28, 16, v30
    v_and_b32 v29, s67, v30
    v_mul_f32 v28, v28, v37
    v_mul_f32 v29, v29, v37
    v_cvt_pk_bf16_f32 v14, v28, v29
    v_lshlrev_b32 v28, 16, v15
    v_and_b32 v29, s67, v15
    v_sub_f32 v28, v28, v36
    v_sub_f32 v29, v29, v36
    v_cvt_pk_bf16_f32 v30, v28, v29
    v_lshlrev_b32 v28, 16, v30
    v_and_b32 v29, s67, v30
    v_mul_f32 v28, v28, v37
    v_mul_f32 v29, v29, v37
    v_cvt_pk_bf16_f32 v15, v28, v29
    v_lshlrev_b32 v28, 16, v16
    v_and_b32 v29, s67, v16
    v_sub_f32 v28, v28, v36
    v_sub_f32 v29, v29, v36
    v_cvt_pk_bf16_f32 v30, v28, v29
    v_lshlrev_b32 v28, 16, v30
    v_and_b32 v29, s67, v30
    v_mul_f32 v28, v28, v37
    v_mul_f32 v29, v29, v37
    v_cvt_pk_bf16_f32 v16, v28, v29
    v_lshlrev_b32 v28, 16, v17
    v_and_b32 v29, s67, v17
    v_sub_f32 v28, v28, v36
    v_sub_f32 v29, v29, v36
    v_cvt_pk_bf16_f32 v30, v28, v29
    v_lshlrev_b32 v28, 16, v30
    v_and_b32 v29, s67, v30
    v_mul_f32 v28, v28, v37
    v_mul_f32 v29, v29, v37
    v_cvt_pk_bf16_f32 v17, v28, v29
    v_lshlrev_b32 v28, 16, v18
    v_and_b32 v29, s67, v18
    v_sub_f32 v28, v28, v36
    v_sub_f32 v29, v29, v36
    v_cvt_pk_bf16_f32 v30, v28, v29
    v_lshlrev_b32 v28, 16, v30
    v_and_b32 v29, s67, v30
    v_mul_f32 v28, v28, v37
    v_mul_f32 v29, v29, v37
    v_cvt_pk_bf16_f32 v18, v28, v29
    v_lshlrev_b32 v28, 16, v19
    v_and_b32 v29, s67, v19
    v_sub_f32 v28, v28, v36
    v_sub_f32 v29, v29, v36
    v_cvt_pk_bf16_f32 v30, v28, v29
    v_lshlrev_b32 v28, 16, v30
    v_and_b32 v29, s67, v30
    v_mul_f32 v28, v28, v37
    v_mul_f32 v29, v29, v37
    v_cvt_pk_bf16_f32 v19, v28, v29
    s_load_dword s43, s[24:25], 0
    s_waitcnt vmcnt(0)
    v_perm_b32 v104, v12, v12, v20
    v_perm_b32 v105, v12, v12, v21
    v_perm_b32 v106, v12, v12, v22
    v_perm_b32 v107, v12, v12, v23
    s_nop 1
    v_mfma_f32_16x16x32_bf16 v[24:27], v[40:43], v[104:107], 0
    v_lshrrev_b32 v12, 16, v12
    v_perm_b32 v108, v12, v12, v20
    v_perm_b32 v109, v12, v12, v21
    v_perm_b32 v110, v12, v12, v22
    v_perm_b32 v111, v12, v12, v23
    s_nop 1
    v_mfma_f32_16x16x32_bf16 v[24:27], v[44:47], v[108:111], v[24:27]
    v_perm_b32 v104, v13, v13, v20
    v_perm_b32 v105, v13, v13, v21
    v_perm_b32 v106, v13, v13, v22
    v_perm_b32 v107, v13, v13, v23
    s_nop 1
    v_mfma_f32_16x16x32_bf16 v[24:27], v[48:51], v[104:107], v[24:27]
    v_lshrrev_b32 v13, 16, v13
    v_perm_b32 v108, v13, v13, v20
    v_perm_b32 v109, v13, v13, v21
    v_perm_b32 v110, v13, v13, v22
    v_perm_b32 v111, v13, v13, v23
    s_nop 1
    v_mfma_f32_16x16x32_bf16 v[24:27], v[52:55], v[108:111], v[24:27]
    v_perm_b32 v104, v14, v14, v20
    v_perm_b32 v105, v14, v14, v21
    v_perm_b32 v106, v14, v14, v22
    v_perm_b32 v107, v14, v14, v23
    s_nop 1
    v_mfma_f32_16x16x32_bf16 v[24:27], v[56:59], v[104:107], v[24:27]
    v_lshrrev_b32 v14, 16, v14
    v_perm_b32 v108, v14, v14, v20
    v_perm_b32 v109, v14, v14, v21
    v_perm_b32 v110, v14, v14, v22
    v_perm_b32 v111, v14, v14, v23
    s_nop 1
    v_mfma_f32_16x16x32_bf16 v[24:27], v[60:63], v[108:111], v[24:27]
    v_perm_b32 v104, v15, v15, v20
    v_perm_b32 v105, v15, v15, v21
    v_perm_b32 v106, v15, v15, v22
    v_perm_b32 v107, v15, v15, v23
    s_nop 1
    v_mfma_f32_16x16x32_bf16 v[24:27], v[64:67], v[104:107], v[24:27]
    v_lshrrev_b32 v15, 16, v15
    v_perm_b32 v108, v15, v15, v20
    v_perm_b32 v109, v15, v15, v21
    v_perm_b32 v110, v15, v15, v22
    v_perm_b32 v111, v15, v15, v23
    s_nop 1
    v_mfma_f32_16x16x32_bf16 v[24:27], v[68:71], v[108:111], v[24:27]
    v_perm_b32 v104, v16, v16, v20
    v_perm_b32 v105, v16, v16, v21
    v_perm_b32 v106, v16, v16, v22
    v_perm_b32 v107, v16, v16, v23
    s_nop 1
    v_mfma_f32_16x16x32_bf16 v[24:27], v[72:75], v[104:107], v[24:27]
    v_lshrrev_b32 v16, 16, v16
    v_perm_b32 v108, v16, v16, v20
    v_perm_b32 v109, v16, v16, v21
    v_perm_b32 v110, v16, v16, v22
    v_perm_b32 v111, v16, v16, v23
    s_nop 1
    v_mfma_f32_16x16x32_bf16 v[24:27], v[76:79], v[108:111], v[24:27]
    v_perm_b32 v104, v17, v17, v20
    v_perm_b32 v105, v17, v17, v21
    v_perm_b32 v106, v17, v17, v22
    v_perm_b32 v107, v17, v17, v23
    s_nop 1
    v_mfma_f32_16x16x32_bf16 v[24:27], v[80:83], v[104:107], v[24:27]
    v_lshrrev_b32 v17, 16, v17
    v_perm_b32 v108, v17, v17, v20
    v_perm_b32 v109, v17, v17, v21
    v_perm_b32 v110, v17, v17, v22
    v_perm_b32 v111, v17, v17, v23
    s_nop 1
    v_mfma_f32_16x16x32_bf16 v[24:27], v[84:87], v[108:111], v[24:27]
    v_perm_b32 v104, v18, v18, v20
    v_perm_b32 v105, v18, v18, v21
    v_perm_b32 v106, v18, v18, v22
    v_perm_b32 v107, v18, v18, v23
    s_nop 1
    v_mfma_f32_16x16x32_bf16 v[24:27], v[88:91], v[104:107], v[24:27]
    v_lshrrev_b32 v18, 16, v18
    v_perm_b32 v108, v18, v18, v20
    v_perm_b32 v109, v18, v18, v21
    v_perm_b32 v110, v18, v18, v22
    v_perm_b32 v111, v18, v18, v23
    s_nop 1
    v_mfma_f32_16x16x32_bf16 v[24:27], v[92:95], v[108:111], v[24:27]
    v_perm_b32 v104, v19, v19, v20
    v_perm_b32 v105, v19, v19, v21
    v_perm_b32 v106, v19, v19, v22
    v_perm_b32 v107, v19, v19, v23
    s_nop 1
    v_mfma_f32_16x16x32_bf16 v[24:27], v[96:99], v[104:107], v[24:27]
    v_lshrrev_b32 v19, 16, v19
    v_perm_b32 v108, v19, v19, v20
    v_perm_b32 v109, v19, v19, v21
    v_perm_b32 v110, v19, v19, v22
    v_perm_b32 v111, v19, v19, v23
    s_nop 1
    v_mfma_f32_16x16x32_bf16 v[24:27], v[100:103], v[108:111], v[24:27]
    s_mov_b32 s28, s24
    s_mov_b32 s29, s25
    s_mov_b32 s30, 0x100
    s_mov_b32 s31, 0x20000
    s_mov_b32 s58, 60000
    s_waitcnt lgkmcnt(0)
    s_cmp_lg_u32 s43, 0
    s_cbranch_scc1 L_num_ok
    s_load_dword s43, s[24:25], 64
    s_waitcnt lgkmcnt(0)
    s_cmp_lg_u32 s43, 0
    s_cbranch_scc1 L_num_ok
    s_sleep 12
    s_load_dword s43, s[24:25], 128
    s_waitcnt lgkmcnt(0)
    s_cmp_lg_u32 s43, 0
    s_cbranch_scc1 L_num_ok
    s_sleep 12
    s_load_dword s43, s[24:25], 192
    v_mov_b32 v3, 0
    s_waitcnt lgkmcnt(0)
L_num:
    s_cmp_lg_u32 s43, 0
    s_cbranch_scc1 L_num_ok
    s_sub_u32 s58, s58, 1
    s_cbranch_scc1 L_num_ok
    buffer_load_dword v4, v3, s[28:31], 0 offen sc1
    s_waitcnt vmcnt(0)
    v_readfirstlane_b32 s43, v4
    s_branch L_num
L_num_ok:
    s_and_b32 s56, s43, s42
    v_mov_b32 v38, s56
    s_getreg_b32 s77, hwreg(HW_REG_XCC_ID)
    s_and_b32 s77, s77, 15
    s_bfe_u32 s76, s43, 0x3001c
    s_lshl_b32 s43, s43, 4
    s_or_b32 s43, s43, s77
    s_lshl_b32 s56, s54, 9
    v_lshrrev_b32 v2, 4, v0
    v_and_b32 v3, 7, v0
    v_lshl_add_u32 v2, v2, 3, v3
    v_lshl_add_u32 v2, v2, 4, s56
    v_bfi_b32 v24, s42, v38, v24
    s_mov_b32 exec_lo, 0x00ff00ff
    s_mov_b32 exec_hi, 0x00ff00ff
    buffer_store_dwordx4 v[24:27], v2, s[36:39], 0 offen sc1
    s_mov_b64 exec, -1
    s_lshl_b32 s57, s52, 7
    s_add_u32 s57, s57, 266240
    v_lshl_add_u32 v5, v3, 2, s57
    s_cmp_eq_u32 s41, 0
    s_cbranch_scc0 L_noxc
    s_lshl_b32 s56, s55, 2
    s_add_u32 s56, s56, s57
    v_mov_b32 v3, s56
    v_mov_b32 v4, s43
    s_mov_b64 exec, 1
    buffer_store_dword v4, v3, s[36:39], 0 offen sc1
    s_mov_b64 exec, -1
L_noxc:
    s_and_b32 s56, s54, 0xf8
    s_lshl_b32 s56, s56, 9
    v_add_u32 v7, s56, v8
    v_bfe_u32 v2, v0, 3, 2
    v_lshlrev_b32 v2, 2, v2
    v_lshrrev_b32 v3, 5, v0
    v_add_u32 v2, v2, v3
    v_and_b32 v3, 7, v0
    v_lshl_add_u32 v2, v2, 3, v3
    v_lshlrev_b32 v2, 1, v2
    s_lshl_b32 s56, s54, 9
    s_add_u32 s56, s56, 131072
    v_lshl_add_u32 v9, v0, 3, s56
    buffer_load_dword v28, v9, s[36:39], 0 offen
    s_lshl_b32 s56, s54, 4
    s_add_u32 s56, s56, 262144
    v_mov_b32 v9, s56
    buffer_load_dword v29, v9, s[36:39], 0 offen
    s_waitcnt vmcnt(0)
    buffer_load_dwordx4 v[112:115], v7, s[36:39], 0 offen offset:0 sc1
    buffer_load_dwordx4 v[116:119], v7, s[36:39], 0 offen offset:1024 sc1
    buffer_load_dwordx4 v[120:123], v7, s[36:39], 0 offen offset:2048 sc1
    buffer_load_dwordx4 v[124:127], v7, s[36:39], 0 offen offset:3072 sc1
    buffer_load_dword v6, v5, s[36:39], 0 offen sc1
    s_mov_b32 s58, 60000
L_poll5:
    s_waitcnt vmcnt(0)
    v_xor_b32 v112, v112, v38
    v_xor_b32 v116, v116, v38
    v_xor_b32 v120, v120, v38
    v_xor_b32 v124, v124, v38
    v_or3_b32 v10, v112, v116, v120
    v_bitop3_b32 v10, v10, v124, s42 bitop3:0xa8
    v_cmp_ne_u32 vcc, 0, v10
    s_cbranch_vccz L_ok5
    s_sub_u32 s58, s58, 1
    s_cbranch_scc1 L_ok5
    buffer_load_dwordx4 v[112:115], v7, s[36:39], 0 offen offset:0 sc1
    buffer_load_dwordx4 v[116:119], v7, s[36:39], 0 offen offset:1024 sc1
    buffer_load_dwordx4 v[120:123], v7, s[36:39], 0 offen offset:2048 sc1
    buffer_load_dwordx4 v[124:127], v7, s[36:39], 0 offen offset:3072 sc1
    buffer_load_dword v6, v5, s[36:39], 0 offen sc1
    s_branch L_poll5
L_ok5:
    v_cmp_ne_u32 vcc, s43, v6
    s_nop 0
    s_cmp_eq_u64 vcc, 0
    s_cselect_b32 s59, 1, 0
    v_mov_b32 v4, s59
    v_mov_b32 v5, v38
    v_mov_b32 v6, s76
    ds_write_b64 v33, v[4:5] offset:48
    ds_write_b32 v33, v6 offset:56
    v_add_f32 v112, v112, v116
    v_add_f32 v120, v120, v124
    v_add_f32 v113, v113, v117
    v_add_f32 v121, v121, v125
    v_add_f32 v114, v114, v118
    v_add_f32 v122, v122, v126
    v_add_f32 v115, v115, v119
    v_add_f32 v123, v123, v127
    v_add_f32 v112, v112, v120
    v_add_f32 v113, v113, v121
    v_add_f32 v114, v114, v122
    v_add_f32 v115, v115, v123
    v_permlane32_swap_b32 v112, v113
    s_nop 0
    v_permlane32_swap_b32 v114, v115
    v_add_f32 v112, v112, v113
    v_add_f32 v114, v114, v115
    v_cvt_pk_bf16_f32 v112, v112, v114
    ds_write_b16 v2, v112 offset:0
    ds_write_b16_d16_hi v2, v112 offset:32
    ds_write_b32 v33, v39 offset:24
    s_mov_b32 s28, s12
    s_mov_b32 s29, s13
    s_mov_b32 s30, 0x400000
    s_mov_b32 s31, 0x20000
    v_and_b32 v1, 15, v0
    v_lshlrev_b32 v1, 10, v1
    s_lshl_b32 s56, s54, 14
    s_add_u32 s56, s56, 384
    buffer_load_dword v162, v1, s[28:31], s56 offen
L_roles:
    s_cmp_eq_u32 s41, 1
    s_cbranch_scc1 L_mlp
    s_cmp_eq_u32 s41, 0
    s_cbranch_scc1 L_z
    s_cmp_eq_u32 s3, 0
    s_cbranch_scc0 L_idle
    s_cmp_lt_u32 s55, 8
    s_cbranch_scc0 L_idle
L_spin6:
    ds_read_b32 v10, v33 offset:32
    s_waitcnt lgkmcnt(0)
    v_readfirstlane_b32 s56, v10
    s_nop 0
    s_cmp_ge_u32 s56, 1
    s_cbranch_scc1 L_spun6
    s_sleep 4
    s_branch L_spin6
L_spun6:
    v_mov_b32 v17, 4
    global_load_dword v18, v17, s[24:25] sc1
    s_waitcnt vmcnt(0)
    s_mov_b32 s58, 60000
L_loc7:
    v_readfirstlane_b32 s56, v18
    s_nop 0
    s_cmp_lg_u32 s56, 0
    s_cbranch_scc1 L_locok7
    s_sub_u32 s58, s58, 1
    s_cbranch_scc1 L_locok7
    global_load_dword v18, v17, s[24:25] sc1
    s_waitcnt vmcnt(0)
    s_branch L_loc7
L_locok7:
    s_getreg_b32 s57, hwreg(HW_REG_XCC_ID)
    s_lshl_b32 s56, s56, 2
    s_xor_b32 s76, s76, s56
    s_and_b32 s76, s76, 7
    s_xor_b32 s56, s56, s57
    s_lshl_b32 s56, s56, 11
    s_and_b32 s56, s56, 0x2000
    s_or_b32 s76, s76, s56
    s_lshl_b32 s56, s52, 3
    s_add_u32 s56, s56, s55
    s_lshl_b32 s56, s56, 3
    s_add_u32 s56, s56, 4
    s_and_b32 s77, s76, 0x2000
    s_add_u32 s77, s77, 294912
    v_lshrrev_b32 v20, 4, v0
    v_add_u32 v20, s56, v20
    v_lshlrev_b32 v21, 1, v20
    v_lshl_add_u32 v20, v20, 2, s77
    s_lshl_b32 s56, s56, 2
    s_and_b32 s57, s56, 0x780
    s_add_u32 s57, s57, s77
    v_bfe_u32 v27, v0, 3, 2
    v_lshlrev_b32 v27, 11, v27
    v_lshrrev_b32 v22, 5, v0
    v_lshl_add_u32 v27, v22, 14, v27
    v_and_b32 v23, 7, v0
    v_lshl_add_u32 v27, v23, 4, v27
    v_add_u32 v27, s57, v27
    s_add_u32 s57, s52, s76
    s_lshl_b32 s78, s57, 11
    s_and_b32 s78, s78, 0x2000
    s_and_b32 s57, s57, 3
    s_lshl_b32 s57, s57, 8
    s_or_b32 s57, s57, s78
    s_and_b32 s56, s56, 0xff
    s_add_u32 s56, s56, s57
    s_add_u32 s56, s56, 327680
    v_lshrrev_b32 v22, 3, v0
    v_lshlrev_b32 v22, 14, v22
    v_lshl_add_u32 v22, v23, 10, v22
    v_add_u32 v22, s56, v22
    v_add_u32 v23, 131072, v22
    s_mov_b32 s32, s22
    s_mov_b32 s33, s23
    s_mov_b32 s34, 0x400
    s_mov_b32 s35, 0x20000
    buffer_load_ushort v26, v21, s[48:51], 0 offen
    s_sleep 18
    s_branch L_fin
L_z:
    s_mov_b32 s28, s12
    s_mov_b32 s29, s13
    s_mov_b32 s30, 0x400000
    s_mov_b32 s31, 0x20000
    s_lshl_b32 s56, s52, 2
    s_add_u32 s56, s56, s3
    s_lshl_b32 s56, s56, 17
    s_lshl_b32 s57, s55, 7
    s_add_u32 s56, s56, s57
    v_bfe_u32 v1, v0, 3, 2
    v_lshrrev_b32 v2, 5, v0
    v_lshl_add_u32 v1, v1, 3, v2
    v_lshlrev_b32 v1, 10, v1
    v_and_b32 v2, 7, v0
    v_lshl_add_u32 v1, v2, 4, v1
    v_add_u32 v1, s56, v1
    s_lshl_b32 s65, s3, 14
    s_add_u32 s65, s65, 10240
    v_lshrrev_b32 v3, 4, v0
    v_lshlrev_b32 v3, 3, v3
    v_bfe_u32 v4, v0, 2, 2
    v_add_u32 v3, v3, v4
    v_lshlrev_b32 v3, 7, v3
    v_and_b32 v4, 3, v0
    v_lshl_add_u32 v3, v4, 3, v3
    v_add_u32 v3, s65, v3
    s_lshl_b32 s56, s52, 5
    s_lshl_b32 s57, s3, 3
    s_add_u32 s56, s56, s57
    s_lshl_b32 s57, s56, 9
    s_add_u32 s57, s57, 131072
    v_add_u32 v4, s57, v8
    s_lshl_b32 s57, s56, 4
    s_add_u32 s57, s57, 262144
    v_lshl_add_u32 v5, v2, 4, s57
    s_lshl_b32 s56, s3, 8
    s_add_u32 s57, s56, 1536
    v_lshl_add_u32 v25, v0, 2, s57
    s_add_u32 s56, s56, 3072
    v_lshrrev_b32 v7, 4, v0
    v_lshl_add_u32 v7, v7, 4, s56
    v_and_b32 v9, 31, v0
    v_lshlrev_b32 v9, 3, v9
    v_lshrrev_b32 v10, 5, v0
    v_lshl_add_u32 v9, v10, 2, v9
    v_add_u32 v9, s56, v9
    s_lshr_b32 s56, s52, 2
    s_lshl_b32 s56, s56, 14
    s_and_b32 s57, s52, 3
    s_lshl_b32 s57, s57, 11
    s_add_u32 s56, s56, s57
    s_lshl_b32 s57, s55, 8
    s_add_u32 s56, s56, s57
    s_add_u32 s56, s56, 294912
    v_and_b32 v6, 15, v0
    v_lshlrev_b32 v6, 4, v6
    v_bfe_u32 v10, v0, 4, 1
    v_lshl_add_u32 v24, v10, 13, v6
    v_add_u32 v24, s56, v24
L_spin8:
    ds_read_b32 v10, v33 offset:28
    ds_read_b32 v38, v33 offset:52
    ds_read_b32 v11, v33 offset:56
    s_waitcnt lgkmcnt(0)
    v_readfirstlane_b32 s56, v10
    s_nop 0
    s_cmp_ge_u32 s56, s40
    s_cbranch_scc1 L_spun8
    s_sleep 4
    s_branch L_spin8
L_spun8:
    v_readfirstlane_b32 s76, v11
    buffer_load_dword v28, v24, s[36:39], 0 offen
    s_add_u32 m0, s65, 0
    s_mov_b32 s57, 0
    buffer_load_dwordx4 v1, s[28:31], s57 offen nt lds
    s_add_u32 m0, s65, 1024
    s_mov_b32 s57, 2048
    buffer_load_dwordx4 v1, s[28:31], s57 offen nt lds
    s_add_u32 m0, s65, 2048
    s_mov_b32 s57, 4096
    buffer_load_dwordx4 v1, s[28:31], s57 offen nt lds
    s_add_u32 m0, s65, 3072
    s_mov_b32 s57, 6144
    buffer_load_dwordx4 v1, s[28:31], s57 offen nt lds
    s_add_u32 m0, s65, 4096
    s_mov_b32 s57, 32768
    buffer_load_dwordx4 v1, s[28:31], s57 offen nt lds
    s_add_u32 m0, s65, 5120
    s_mov_b32 s57, 34816
    buffer_load_dwordx4 v1, s[28:31], s57 offen nt lds
    s_add_u32 m0, s65, 6144
    s_mov_b32 s57, 36864
    buffer_load_dwordx4 v1, s[28:31], s57 offen nt lds
    s_add_u32 m0, s65, 7168
    s_mov_b32 s57, 38912
    buffer_load_dwordx4 v1, s[28:31], s57 offen nt lds
    s_add_u32 m0, s65, 8192
    s_mov_b32 s57, 65536
    buffer_load_dwordx4 v1, s[28:31], s57 offen nt lds
    s_add_u32 m0, s65, 9216
    s_mov_b32 s57, 67584
    buffer_load_dwordx4 v1, s[28:31], s57 offen nt lds
    s_add_u32 m0, s65, 10240
    s_mov_b32 s57, 69632
    buffer_load_dwordx4 v1, s[28:31], s57 offen nt lds
    s_add_u32 m0, s65, 11264
    s_mov_b32 s57, 71680
    buffer_load_dwordx4 v1, s[28:31], s57 offen nt lds
    s_add_u32 m0, s65, 12288
    s_mov_b32 s57, 98304
    buffer_load_dwordx4 v1, s[28:31], s57 offen nt lds
    s_add_u32 m0, s65, 13312
    s_mov_b32 s57, 100352
    buffer_load_dwordx4 v1, s[28:31], s57 offen nt lds
    s_add_u32 m0, s65, 14336
    s_mov_b32 s57, 102400
    buffer_load_dwordx4 v1, s[28:31], s57 offen nt lds
    s_add_u32 m0, s65, 15360
    s_mov_b32 s57, 104448
    buffer_load_dwordx4 v1, s[28:31], s57 offen nt lds
    v_mov_b32 v17, 4
    global_load_dword v18, v17, s[24:25] sc1
    s_waitcnt vmcnt(0)
    ds_read_b64_tr_b16 v[40:41], v3 offset:0
    ds_read_b64_tr_b16 v[42:43], v3 offset:512
    ds_read_b64_tr_b16 v[44:45], v3 offset:32
    ds_read_b64_tr_b16 v[46:47], v3 offset:544
    ds_read_b64_tr_b16 v[48:49], v3 offset:64
    ds_read_b64_tr_b16 v[50:51], v3 offset:576
    ds_read_b64_tr_b16 v[52:53], v3 offset:96
    ds_read_b64_tr_b16 v[54:55], v3 offset:608
    ds_read_b64_tr_b16 v[56:57], v3 offset:4096
    ds_read_b64_tr_b16 v[58:59], v3 offset:4608
    ds_read_b64_tr_b16 v[60:61], v3 offset:4128
    ds_read_b64_tr_b16 v[62:63], v3 offset:4640
    ds_read_b64_tr_b16 v[64:65], v3 offset:4160
    ds_read_b64_tr_b16 v[66:67], v3 offset:4672
    ds_read_b64_tr_b16 v[68:69], v3 offset:4192
    ds_read_b64_tr_b16 v[70:71], v3 offset:4704
    ds_read_b64_tr_b16 v[72:73], v3 offset:8192
    ds_read_b64_tr_b16 v[74:75], v3 offset:8704
    ds_read_b64_tr_b16 v[76:77], v3 offset:8224
    ds_read_b64_tr_b16 v[78:79], v3 offset:8736
    ds_read_b64_tr_b16 v[80:81], v3 offset:8256
    ds_read_b64_tr_b16 v[82:83], v3 offset:8768
    ds_read_b64_tr_b16 v[84:85], v3 offset:8288
    ds_read_b64_tr_b16 v[86:87], v3 offset:8800
    ds_read_b64_tr_b16 v[88:89], v3 offset:12288
    ds_read_b64_tr_b16 v[90:91], v3 offset:12800
    ds_read_b64_tr_b16 v[92:93], v3 offset:12320
    ds_read_b64_tr_b16 v[94:95], v3 offset:12832
    ds_read_b64_tr_b16 v[96:97], v3 offset:12352
    ds_read_b64_tr_b16 v[98:99], v3 offset:12864
    ds_read_b64_tr_b16 v[100:101], v3 offset:12384
    ds_read_b64_tr_b16 v[102:103], v3 offset:12896
    s_mov_b32 s58, 60000
L_loc9:
    v_readfirstlane_b32 s56, v18
    s_nop 0
    s_cmp_lg_u32 s56, 0
    s_cbranch_scc1 L_locok9
    s_sub_u32 s58, s58, 1
    s_cbranch_scc1 L_locok9
    global_load_dword v18, v17, s[24:25] sc1
    s_waitcnt vmcnt(0)
    s_branch L_loc9
L_locok9:
    s_getreg_b32 s57, hwreg(HW_REG_XCC_ID)
    s_lshl_b32 s56, s56, 2
    s_xor_b32 s76, s76, s56
    s_and_b32 s76, s76, 7
    s_xor_b32 s56, s56, s57
    s_lshl_b32 s56, s56, 11
    s_and_b32 s56, s56, 0x2000
    s_or_b32 s76, s76, s56
    s_lshl_b32 s56, s52, 3
    s_add_u32 s56, s56, s55
    s_lshl_b32 s56, s56, 3
    s_and_b32 s77, s76, 0x2000
    s_add_u32 s77, s77, 294912
    v_lshrrev_b32 v20, 4, v0
    v_add_u32 v20, s56, v20
    v_lshlrev_b32 v21, 1, v20
    v_lshl_add_u32 v20, v20, 2, s77
    s_lshl_b32 s56, s56, 2
    s_and_b32 s57, s56, 0x780
    s_add_u32 s57, s57, s77
    v_bfe_u32 v27, v0, 3, 2
    v_lshlrev_b32 v27, 11, v27
    v_lshrrev_b32 v22, 5, v0
    v_lshl_add_u32 v27, v22, 14, v27
    v_and_b32 v23, 7, v0
    v_lshl_add_u32 v27, v23, 4, v27
    v_add_u32 v27, s57, v27
    s_add_u32 s57, s52, s76
    s_lshl_b32 s78, s57, 11
    s_and_b32 s78, s78, 0x2000
    s_and_b32 s57, s57, 3
    s_lshl_b32 s57, s57, 8
    s_or_b32 s57, s57, s78
    s_and_b32 s56, s56, 0xff
    s_add_u32 s56, s56, s57
    s_add_u32 s56, s56, 327680
    v_lshrrev_b32 v22, 3, v0
    v_lshlrev_b32 v22, 14, v22
    v_lshl_add_u32 v22, v23, 10, v22
    v_add_u32 v22, s56, v22
    v_add_u32 v23, 131072, v22
    s_mov_b32 s32, s22
    s_mov_b32 s33, s23
    s_mov_b32 s34, 0x400
    s_mov_b32 s35, 0x20000
    buffer_load_ushort v26, v21, s[48:51], 0 offen
    buffer_load_dwordx4 v[120:123], v5, s[36:39], 0 offen sc1
    s_mov_b32 s58, 60000
L_poll10:
    s_waitcnt vmcnt(0)
    v_xor_b32 v120, v120, v38
    v_xor_b32 v121, v121, v38
    v_xor_b32 v122, v122, v38
    v_xor_b32 v123, v123, v38
    v_or3_b32 v10, v120, v121, v122
    v_bitop3_b32 v10, v10, v123, s42 bitop3:0xa8
    v_cmp_ne_u32 vcc, 0, v10
    s_cbranch_vccz L_ok10
    s_sub_u32 s58, s58, 1
    s_cbranch_scc1 L_ok10
    buffer_load_dwordx4 v[120:123], v5, s[36:39], 0 offen sc1
    s_branch L_poll10
L_ok10:
    v_max_f32_dpp v16, v120, v120 quad_perm:[1,0,3,2] row_mask:0xf bank_mask:0xf
    s_nop 1
    v_max_f32_dpp v16, v16, v16 quad_perm:[2,3,0,1] row_mask:0xf bank_mask:0xf
    s_nop 1
    v_max_f32_dpp v16, v16, v16 row_half_mirror row_mask:0xf bank_mask:0xf
    v_sub_f32 v16, v120, v16
    v_exp_f32 v16, v16
    s_nop 0
    v_mul_f32 v11, v16, v121
    s_nop 1
    v_add_f32_dpp v11, v11, v11 quad_perm:[1,0,3,2] row_mask:0xf bank_mask:0xf
    s_nop 1
    v_add_f32_dpp v11, v11, v11 quad_perm:[2,3,0,1] row_mask:0xf bank_mask:0xf
    s_nop 1
    v_add_f32_dpp v11, v11, v11 row_half_mirror row_mask:0xf bank_mask:0xf
    v_rcp_f32 v11, v11
    s_nop 0
    v_mul_f32 v16, v16, v11
    s_nop 1
    v_mov_b32_dpp v16, v16 row_ror:15 row_mask:0xc bank_mask:0xf
L_spin11:
    ds_read_b32 v10, v33 offset:36
    s_waitcnt lgkmcnt(0)
    v_readfirstlane_b32 s56, v10
    s_nop 0
    s_cmp_ge_u32 s56, s40
    s_cbranch_scc1 L_spun11
    s_sleep 1
    s_branch L_spin11
L_spun11:
    buffer_load_dwordx4 v[104:107], v4, s[36:39], 0 offen offset:0 sc1
    buffer_load_dwordx4 v[108:111], v4, s[36:39], 0 offen offset:1024 sc1
    buffer_load_dwordx4 v[112:115], v4, s[36:39], 0 offen offset:2048 sc1
    buffer_load_dwordx4 v[116:119], v4, s[36:39], 0 offen offset:3072 sc1
    s_mov_b32 s58, 60000
L_poll12:
    s_waitcnt vmcnt(0)
    v_xor_b32 v11, v104, v38
    v_bitop3_b32 v11, v11, v106, v38 bitop3:0xf6
    v_xor_b32 v12, v108, v38
    v_bitop3_b32 v12, v12, v110, v38 bitop3:0xf6
    v_xor_b32 v13, v112, v38
    v_bitop3_b32 v13, v13, v114, v38 bitop3:0xf6
    v_xor_b32 v14, v116, v38
    v_bitop3_b32 v14, v14, v118, v38 bitop3:0xf6
    v_or3_b32 v10, v11, v12, v13
    v_bitop3_b32 v10, v10, v14, s42 bitop3:0xa8
    v_cmp_ne_u32 vcc, 0, v10
    s_cbranch_vccz L_ok12
    s_sub_u32 s58, s58, 1
    s_cbranch_scc1 L_ok12
    v_and_b32 v10, s42, v11
    v_cmp_ne_u32 vcc, 0, v10
    s_cbranch_vccz L_skip12_0
    buffer_load_dwordx4 v[104:107], v4, s[36:39], 0 offen offset:0 sc1
L_skip12_0:
    v_and_b32 v10, s42, v12
    v_cmp_ne_u32 vcc, 0, v10
    s_cbranch_vccz L_skip12_1
    buffer_load_dwordx4 v[108:111], v4, s[36:39], 0 offen offset:1024 sc1
L_skip12_1:
    v_and_b32 v10, s42, v13
    v_cmp_ne_u32 vcc, 0, v10
    s_cbranch_vccz L_skip12_2
    buffer_load_dwordx4 v[112:115], v4, s[36:39], 0 offen offset:2048 sc1
L_skip12_2:
    v_and_b32 v10, s42, v14
    v_cmp_ne_u32 vcc, 0, v10
    s_cbranch_vccz L_skip12_3
    buffer_load_dwordx4 v[116:119], v4, s[36:39], 0 offen offset:3072 sc1
L_skip12_3:
    s_branch L_poll12
L_ok12:
    v_xor_b32 v104, v104, v38
    v_xor_b32 v106, v106, v38
    v_xor_b32 v108, v108, v38
    v_xor_b32 v110, v110, v38
    v_xor_b32 v112, v112, v38
    v_xor_b32 v114, v114, v38
    v_xor_b32 v116, v116, v38
    v_xor_b32 v118, v118, v38
    v_mul_f32_dpp v12, v16, v104 row_newbcast:0 row_mask:0xf bank_mask:0xf
    v_mul_f32_dpp v13, v16, v105 row_newbcast:0 row_mask:0xf bank_mask:0xf
    v_mul_f32_dpp v14, v16, v106 row_newbcast:0 row_mask:0xf bank_mask:0xf
    v_mul_f32_dpp v15, v16, v107 row_newbcast:0 row_mask:0xf bank_mask:0xf
    v_fmac_f32_dpp v12, v16, v108 row_newbcast:2 row_mask:0xf bank_mask:0xf
    v_fmac_f32_dpp v13, v16, v109 row_newbcast:2 row_mask:0xf bank_mask:0xf
    v_fmac_f32_dpp v14, v16, v110 row_newbcast:2 row_mask:0xf bank_mask:0xf
    v_fmac_f32_dpp v15, v16, v111 row_newbcast:2 row_mask:0xf bank_mask:0xf
    v_fmac_f32_dpp v12, v16, v112 row_newbcast:4 row_mask:0xf bank_mask:0xf
    v_fmac_f32_dpp v13, v16, v113 row_newbcast:4 row_mask:0xf bank_mask:0xf
    v_fmac_f32_dpp v14, v16, v114 row_newbcast:4 row_mask:0xf bank_mask:0xf
    v_fmac_f32_dpp v15, v16, v115 row_newbcast:4 row_mask:0xf bank_mask:0xf
    v_fmac_f32_dpp v12, v16, v116 row_newbcast:6 row_mask:0xf bank_mask:0xf
    v_fmac_f32_dpp v13, v16, v117 row_newbcast:6 row_mask:0xf bank_mask:0xf
    v_fmac_f32_dpp v14, v16, v118 row_newbcast:6 row_mask:0xf bank_mask:0xf
    v_fmac_f32_dpp v15, v16, v119 row_newbcast:6 row_mask:0xf bank_mask:0xf
    s_nop 0
    v_permlane32_swap_b32 v12, v14
    v_permlane32_swap_b32 v13, v15
    v_add_f32 v12, v12, v14
    v_add_f32 v13, v13, v15
    v_cvt_pk_bf16_f32 v12, v12, v13
    ds_write_b32 v9, v12
    ds_read_b128 v[124:127], v7 offset:0
    ds_read_b128 v[128:131], v7 offset:64
    ds_read_b128 v[132:135], v7 offset:128
    ds_read_b128 v[136:139], v7 offset:192
    s_waitcnt lgkmcnt(3)
    v_mfma_f32_16x16x32_bf16 v[140:143], v[124:127], v[40:43], 0
    v_mfma_f32_16x16x32_bf16 v[144:147], v[124:127], v[44:47], 0
    v_mfma_f32_16x16x32_bf16 v[148:151], v[124:127], v[48:51], 0
    v_mfma_f32_16x16x32_bf16 v[152:155], v[124:127], v[52:55], 0
    s_waitcnt lgkmcnt(2)
    v_mfma_f32_16x16x32_bf16 v[140:143], v[128:131], v[56:59], v[140:143]
    v_mfma_f32_16x16x32_bf16 v[144:147], v[128:131], v[60:63], v[144:147]
    v_mfma_f32_16x16x32_bf16 v[148:151], v[128:131], v[64:67], v[148:151]
    v_mfma_f32_16x16x32_bf16 v[152:155], v[128:131], v[68:71], v[152:155]
    s_waitcnt lgkmcnt(1)
    v_mfma_f32_16x16x32_bf16 v[140:143], v[132:135], v[72:75], v[140:143]
    v_mfma_f32_16x16x32_bf16 v[144:147], v[132:135], v[76:79], v[144:147]
    v_mfma_f32_16x16x32_bf16 v[148:151], v[132:135], v[80:83], v[148:151]
    v_mfma_f32_16x16x32_bf16 v[152:155], v[132:135], v[84:87], v[152:155]
    s_waitcnt lgkmcnt(0)
    v_mfma_f32_16x16x32_bf16 v[140:143], v[136:139], v[88:91], v[140:143]
    v_mfma_f32_16x16x32_bf16 v[144:147], v[136:139], v[92:95], v[144:147]
    v_mfma_f32_16x16x32_bf16 v[148:151], v[136:139], v[96:99], v[148:151]
    v_mfma_f32_16x16x32_bf16 v[152:155], v[136:139], v[100:103], v[152:155]
    s_nop 5
    v_mov_b32_dpp v140, v144 quad_perm:[0,1,2,3] row_mask:0x2 bank_mask:0xf
    v_mov_b32_dpp v140, v148 quad_perm:[0,1,2,3] row_mask:0x4 bank_mask:0xf
    v_mov_b32_dpp v140, v152 quad_perm:[0,1,2,3] row_mask:0x8 bank_mask:0xf
    ds_write_b32 v25, v140
    s_mov_b64 exec, 1
    ds_add_rtn_u32 v10, v33, v39 offset:40
    s_mov_b32 exec_lo, -1
    ds_read_b128 v[12:15], v6 offset:1536
    ds_read_b128 v[128:131], v6 offset:1792
    ds_read_b128 v[132:135], v6 offset:2048
    ds_read_b128 v[136:139], v6 offset:2304
    s_waitcnt lgkmcnt(2)
    v_readfirstlane_b32 s56, v10
    v_pk_add_f32 v[12:13], v[12:13], v[128:129]
    v_pk_add_f32 v[14:15], v[14:15], v[130:131]
    s_waitcnt lgkmcnt(0)
    v_pk_add_f32 v[132:133], v[132:133], v[136:137]
    v_pk_add_f32 v[134:135], v[134:135], v[138:139]
    v_pk_add_f32 v[12:13], v[12:13], v[132:133]
    v_pk_add_f32 v[14:15], v[14:15], v[134:135]
    v_bfi_b32 v12, s42, v38, v12
    s_cmp_lg_u32 s56, 3
    s_cbranch_scc1 L_z_notlast
    buffer_store_dwordx4 v[12:15], v24, s[36:39], 0 offen sc1
L_z_notlast:
    s_mov_b64 exec, -1
    s_cmp_eq_u32 s3, 1
    s_cbranch_scc1 L_fin
    s_endpgm
L_fin:
    buffer_load_dword v28, v27, s[36:39], 0 offen sc1
    s_mov_b32 s58, 60000
L_poll13:
    s_waitcnt vmcnt(0)
    v_xor_b32 v28, v28, v38
    v_and_b32 v10, s42, v28
    v_cmp_ne_u32 vcc, 0, v10
    s_cbranch_vccz L_ok13
    s_sub_u32 s58, s58, 1
    s_cbranch_scc1 L_ok13
    buffer_load_dword v28, v27, s[36:39], 0 offen sc1
    s_branch L_poll13
L_ok13:
    buffer_load_dword v104, v20, s[36:39], s68 offen offset:0 sc1
    buffer_load_dword v105, v20, s[36:39], s68 offen offset:2048 sc1
    buffer_load_dword v106, v20, s[36:39], s69 offen offset:0 sc1
    buffer_load_dword v107, v20, s[36:39], s69 offen offset:2048 sc1
    buffer_load_dword v108, v20, s[36:39], s72 offen offset:0 sc1
    buffer_load_dword v109, v20, s[36:39], s72 offen offset:2048 sc1
    buffer_load_dword v110, v20, s[36:39], s73 offen offset:0 sc1
    buffer_load_dword v111, v20, s[36:39], s73 offen offset:2048 sc1
    v_mov_b32 v116, 0
    v_mov_b32 v117, 0
    v_mov_b32 v118, 0
    v_mov_b32 v119, 0
    s_waitcnt vmcnt(0)
    s_mov_b64 exec, 0xffff
    v_xor_b32 v104, v104, v38
    v_xor_b32 v105, v105, v38
    v_xor_b32 v106, v106, v38
    v_xor_b32 v107, v107, v38
    v_xor_b32 v108, v108, v38
    v_xor_b32 v109, v109, v38
    v_xor_b32 v110, v110, v38
    v_xor_b32 v111, v111, v38
    s_mov_b64 exec, -1
    v_add_f32 v104, v104, v106
    v_add_f32 v105, v105, v107
    v_add_f32 v104, v104, v108
    v_add_f32 v105, v105, v109
    v_add_f32 v104, v104, v110
    v_add_f32 v105, v105, v111
    v_add_f32 v104, v104, v105
    v_lshlrev_b32 v26, 16, v26
    v_add_f32 v104, v104, v26
    v_cvt_pk_bf16_f32 v104, v104, v104
    v_lshlrev_b32 v104, 16, v104
    s_sleep 23
    buffer_load_dwordx4 v[112:115], v22, s[36:39], 0 offen sc1
    s_mov_b64 exec, 0x3fffff
    buffer_load_dwordx4 v[116:119], v23, s[36:39], 0 offen sc1
    s_mov_b64 exec, -1
    s_mov_b32 s58, 60000
L_poll14:
    s_waitcnt vmcnt(0)
    v_xor_b32 v112, v112, v38
    v_xor_b32 v113, v113, v38
    v_xor_b32 v114, v114, v38
    v_xor_b32 v115, v115, v38
    s_mov_b64 exec, 0x3fffff
    v_xor_b32 v116, v116, v38
    v_xor_b32 v117, v117, v38
    v_xor_b32 v118, v118, v38
    v_xor_b32 v119, v119, v38
    s_mov_b64 exec, -1
    v_or3_b32 v10, v112, v113, v114
    v_or3_b32 v10, v10, v115, v116
    v_or3_b32 v10, v10, v117, v118
    v_bitop3_b32 v10, v10, v119, s42 bitop3:0xa8
    v_cmp_ne_u32 vcc, 0, v10
    s_cbranch_vccz L_ok14
    s_sub_u32 s58, s58, 1
    s_cbranch_scc1 L_ok14
    buffer_load_dwordx4 v[112:115], v22, s[36:39], 0 offen sc1
    s_mov_b64 exec, 0x3fffff
    buffer_load_dwordx4 v[116:119], v23, s[36:39], 0 offen sc1
    s_mov_b64 exec, -1
    s_branch L_poll14
L_ok14:
    v_pk_add_f32 v[112:113], v[112:113], v[116:117]
    v_pk_add_f32 v[114:115], v[114:115], v[118:119]
    s_nop 1
    v_permlane32_swap_b32 v112, v114
    v_permlane32_swap_b32 v113, v115
    v_add_f32 v112, v112, v114
    v_add_f32 v113, v113, v115
    s_nop 1
    v_permlane16_swap_b32 v112, v113
    v_add_f32 v112, v112, v113
    s_nop 1
    v_add_f32_dpp v112, v112, v112 row_ror:8 row_mask:0xf bank_mask:0xf
    s_nop 1
    v_add_f32_dpp v112, v112, v112 row_ror:4 row_mask:0xf bank_mask:0xf
    s_nop 1
    v_add_f32_dpp v112, v112, v112 row_ror:2 row_mask:0xf bank_mask:0xf
    s_nop 1
    v_add_f32_dpp v112, v112, v112 row_ror:1 row_mask:0xf bank_mask:0xf
    v_add_f32 v112, v112, v104
    v_cvt_pk_bf16_f32 v112, v112, v112
    s_mov_b32 exec_lo, 0x00010001
    s_mov_b32 exec_hi, 0x00010001
    buffer_store_short v112, v21, s[32:35], 0 offen
    s_endpgm
L_mlp:
    s_mov_b32 s28, s16
    s_mov_b32 s29, s17
    s_mov_b32 s30, 0x158000
    s_mov_b32 s31, 0x20000
    s_mov_b32 s32, s18
    s_mov_b32 s33, s19
    s_mov_b32 s34, 0x158000
    s_mov_b32 s35, 0x20000
    s_mov_b32 s44, s20
    s_mov_b32 s45, s21
    s_mov_b32 s46, 0x158000
    s_mov_b32 s47, 0x20000
    s_lshl_b32 s56, s3, 7
    v_lshrrev_b32 v1, 1, v0
    v_add_u32 v1, s56, v1
    v_mul_u32_u24 v1, 2752, v1
    v_and_b32 v2, 1, v0
    v_lshl_add_u32 v1, v2, 4, v1
    s_lshl_b32 s56, s55, 5
    v_add_u32 v1, s56, v1
    s_lshl_b32 s65, s3, 14
    s_add_u32 s65, s65, 10240
    v_lshrrev_b32 v3, 4, v0
    v_lshlrev_b32 v3, 3, v3
    v_bfe_u32 v4, v0, 2, 2
    v_add_u32 v3, v3, v4
    v_lshlrev_b32 v3, 5, v3
    v_and_b32 v2, 3, v0
    v_lshl_add_u32 v3, v2, 3, v3
    v_add_u32 v3, s65, v3
    s_lshl_b32 s56, s3, 9
    s_add_u32 s56, s56, 294912
    v_lshrrev_b32 v2, 5, v0
    v_and_b32 v21, 31, v0
    v_lshlrev_b32 v4, 11, v2
    v_lshl_add_u32 v4, v21, 4, v4
    v_add_u32 v4, s56, v4
    v_lshlrev_b32 v21, 3, v21
    v_lshl_add_u32 v5, v2, 2, v21
    s_lshl_b32 s56, s3, 8
    v_add_u32 v5, s56, v5
    v_add_u32 v6, 3072, v5
    s_add_u32 s56, s56, 3072
    v_lshrrev_b32 v7, 4, v0
    v_lshl_add_u32 v7, v7, 4, s56
    s_lshl_b32 s56, s55, 14
    s_lshl_b32 s57, s3, 8
    s_add_u32 s56, s56, s57
    v_lshrrev_b32 v20, 4, v0
    v_lshlrev_b32 v20, 10, v20
    v_and_b32 v22, 15, v0
    v_lshl_add_u32 v20, v22, 4, v20
    v_add_u32 v20, s56, v20
    s_add_u32 s56, s65, 8192
    v_lshl_add_u32 v19, v0, 2, s56
    v_lshlrev_b32 v22, 3, v22
    s_lshl_b32 s56, s3, 7
    s_add_u32 s56, s56, 1536
    v_add_u32 v25, s56, v22
    v_lshlrev_b32 v23, 2, v2
    v_add_u32 v23, 272, v23
    v_mov_b32 v24, 272
    v_mov_b32 v116, 0x3f803f80
    v_mov_b32 v117, 0x3f803f80
    v_mov_b32 v118, 0x3f803f80
    v_mov_b32 v119, 0x3f803f80
    s_mov_b32 s60, 0x05040100
    s_mov_b32 s61, 0x07060302
    v_mov_b32 v30, 0
    v_mov_b32 v31, 0
    v_mov_b32 v29, 0x3b000000
    s_lshr_b32 s79, s55, 3
    s_lshl_b32 s79, s79, 14
    s_and_b32 s78, s55, 7
    s_lshl_b32 s78, s78, 10
    s_add_u32 s79, s79, s78
    s_add_u32 s79, s79, 327680
    v_bfe_u32 v9, v0, 3, 1
    v_lshlrev_b32 v9, 13, v9
    v_and_b32 v10, 7, v0
    v_lshl_add_u32 v9, v10, 7, v9
    v_add_u32 v9, s79, v9
L_spin15:
    ds_read_b32 v10, v33 offset:28
    ds_read_b32 v38, v33 offset:52
    ds_read_b32 v11, v33 offset:56
    s_waitcnt lgkmcnt(0)
    v_readfirstlane_b32 s56, v10
    s_nop 0
    s_cmp_ge_u32 s56, s40
    s_cbranch_scc1 L_spun15
    s_sleep 4
    s_branch L_spin15
L_spun15:
    v_readfirstlane_b32 s76, v11
    buffer_load_dword v26, v5, s[48:51], 0 offen
    buffer_load_dword v28, v9, s[36:39], 0 offen
    v_mov_b32 v17, 4
    global_load_dword v18, v17, s[24:25] sc1
    s_waitcnt vmcnt(0)
    s_mov_b32 s58, 60000
L_loc16:
    v_readfirstlane_b32 s56, v18
    s_nop 0
    s_cmp_lg_u32 s56, 0
    s_cbranch_scc1 L_locok16
    s_sub_u32 s58, s58, 1
    s_cbranch_scc1 L_locok16
    global_load_dword v18, v17, s[24:25] sc1
    s_waitcnt vmcnt(0)
    s_branch L_loc16
L_locok16:
    s_getreg_b32 s57, hwreg(HW_REG_XCC_ID)
    s_lshl_b32 s56, s56, 2
    s_xor_b32 s76, s76, s56
    s_and_b32 s76, s76, 7
    s_xor_b32 s56, s56, s57
    s_lshl_b32 s56, s56, 11
    s_and_b32 s56, s56, 0x2000
    s_or_b32 s76, s76, s56
    s_lshl_b32 s77, s3, 1
    s_add_u32 s56, s77, s76
    s_lshl_b32 s78, s56, 11
    s_and_b32 s78, s78, 0x2000
    s_and_b32 s56, s56, 3
    s_lshl_b32 s56, s56, 8
    s_or_b32 s56, s56, s78
    s_add_u32 s77, s77, 1
    s_add_u32 s57, s77, s76
    s_lshl_b32 s78, s57, 11
    s_and_b32 s78, s78, 0x2000
    s_and_b32 s57, s57, 3
    s_lshl_b32 s57, s57, 8
    s_or_b32 s57, s57, s78
    s_add_u32 s56, s56, s79
    s_add_u32 s57, s57, s79
    v_add_u32 v10, s57, v21
    v_add_u32 v21, s56, v21
    s_mov_b32 exec_lo, 0
    v_mov_b32 v21, v10
    s_mov_b32 exec_lo, -1
    s_and_b32 s56, s76, 0x2000
    v_add_u32 v4, s56, v4
    v_lshlrev_b32 v27, 16, v26
    v_and_b32 v26, s67, v26
L_spin17:
    ds_read_b32 v10, v33 offset:32
    s_waitcnt lgkmcnt(0)
    v_readfirstlane_b32 s56, v10
    s_nop 0
    s_cmp_ge_u32 s56, 1
    s_cbranch_scc1 L_spun17
    s_sleep 1
    s_branch L_spin17
L_spun17:
    s_add_u32 m0, s65, 0
    s_mov_b32 s57, 0
    buffer_load_dwordx4 v1, s[28:31], s57 offen lds
    s_add_u32 m0, s65, 4096
    s_nop 0
    buffer_load_dwordx4 v1, s[32:35], s57 offen lds
    s_add_u32 m0, s65, 1024
    s_mov_b32 s57, 88064
    buffer_load_dwordx4 v1, s[28:31], s57 offen lds
    s_add_u32 m0, s65, 5120
    s_nop 0
    buffer_load_dwordx4 v1, s[32:35], s57 offen lds
    s_add_u32 m0, s65, 2048
    s_mov_b32 s57, 176128
    buffer_load_dwordx4 v1, s[28:31], s57 offen lds
    s_add_u32 m0, s65, 6144
    s_nop 0
    buffer_load_dwordx4 v1, s[32:35], s57 offen lds
    s_add_u32 m0, s65, 3072
    s_mov_b32 s57, 264192
    buffer_load_dwordx4 v1, s[28:31], s57 offen lds
    s_add_u32 m0, s65, 7168
    s_nop 0
    buffer_load_dwordx4 v1, s[32:35], s57 offen lds
    s_add_u32 m0, s65, 8192
    s_nop 0
    buffer_load_dwordx4 v20, s[44:47], s68 offen nt lds
    s_add_u32 m0, s65, 9216
    s_nop 0
    buffer_load_dwordx4 v20, s[44:47], s69 offen nt lds
    s_add_u32 m0, s65, 10240
    s_nop 0
    buffer_load_dwordx4 v20, s[44:47], s70 offen nt lds
    s_add_u32 m0, s65, 11264
    s_nop 0
    buffer_load_dwordx4 v20, s[44:47], s71 offen nt lds
    s_waitcnt vmcnt(0)
    buffer_load_dwordx4 v[72:75], v4, s[36:39], s68 offen sc1
    buffer_load_dwordx4 v[76:79], v4, s[36:39], s69 offen sc1
    buffer_load_dwordx4 v[80:83], v4, s[36:39], s72 offen sc1
    buffer_load_dwordx4 v[84:87], v4, s[36:39], s73 offen sc1
    ds_read_b64_tr_b16 v[40:41], v3 offset:0
    ds_read_b64_tr_b16 v[42:43], v3 offset:128
    ds_read_b64_tr_b16 v[44:45], v3 offset:4096
    ds_read_b64_tr_b16 v[46:47], v3 offset:4224
    ds_read_b64_tr_b16 v[48:49], v3 offset:1024
    ds_read_b64_tr_b16 v[50:51], v3 offset:1152
    ds_read_b64_tr_b16 v[52:53], v3 offset:5120
    ds_read_b64_tr_b16 v[54:55], v3 offset:5248
    ds_read_b64_tr_b16 v[56:57], v3 offset:2048
    ds_read_b64_tr_b16 v[58:59], v3 offset:2176
    ds_read_b64_tr_b16 v[60:61], v3 offset:6144
    ds_read_b64_tr_b16 v[62:63], v3 offset:6272
    ds_read_b64_tr_b16 v[64:65], v3 offset:3072
    ds_read_b64_tr_b16 v[66:67], v3 offset:3200
    ds_read_b64_tr_b16 v[68:69], v3 offset:7168
    ds_read_b64_tr_b16 v[70:71], v3 offset:7296
    ds_read2st64_b32 v[120:121], v19 offset0:0 offset1:1
    ds_read2st64_b32 v[122:123], v19 offset0:2 offset1:3
    ds_read2st64_b32 v[124:125], v19 offset0:4 offset1:5
    ds_read2st64_b32 v[126:127], v19 offset0:6 offset1:7
    ds_read2st64_b32 v[128:129], v19 offset0:8 offset1:9
    ds_read2st64_b32 v[130:131], v19 offset0:10 offset1:11
    ds_read2st64_b32 v[132:133], v19 offset0:12 offset1:13
    ds_read2st64_b32 v[134:135], v19 offset0:14 offset1:15
    s_waitcnt lgkmcnt(0)
    v_mfma_f32_16x16x32_bf16 v[108:111], v[116:119], v[40:43], 0
    v_mfma_f32_16x16x32_bf16 v[112:115], v[116:119], v[44:47], 0
    v_mfma_f32_16x16x32_bf16 v[108:111], v[116:119], v[48:51], v[108:111]
    v_mfma_f32_16x16x32_bf16 v[112:115], v[116:119], v[52:55], v[112:115]
    v_mfma_f32_16x16x32_bf16 v[108:111], v[116:119], v[56:59], v[108:111]
    v_mfma_f32_16x16x32_bf16 v[112:115], v[116:119], v[60:63], v[112:115]
    v_mfma_f32_16x16x32_bf16 v[108:111], v[116:119], v[64:67], v[108:111]
    v_mfma_f32_16x16x32_bf16 v[112:115], v[116:119], v[68:71], v[112:115]
    v_perm_b32 v136, v121, v120, s60
    v_perm_b32 v144, v121, v120, s61
    v_perm_b32 v137, v123, v122, s60
    v_perm_b32 v145, v123, v122, s61
    v_perm_b32 v138, v125, v124, s60
    v_perm_b32 v146, v125, v124, s61
    v_perm_b32 v139, v127, v126, s60
    v_perm_b32 v147, v127, v126, s61
    v_perm_b32 v140, v129, v128, s60
    v_perm_b32 v148, v129, v128, s61
    v_perm_b32 v141, v131, v130, s60
    v_perm_b32 v149, v131, v130, s61
    v_perm_b32 v142, v133, v132, s60
    v_perm_b32 v150, v133, v132, s61
    v_perm_b32 v143, v135, v134, s60
    v_perm_b32 v151, v135, v134, s61
    s_mov_b64 exec, 0xffff
    ds_add_f32 v22, v108 offset:1024
    ds_add_f32 v22, v112 offset:1028
    s_mov_b64 exec, -1
    s_mov_b32 s58, 60000
L_poll18:
    s_waitcnt vmcnt(0)
    v_xor_b32 v11, v72, v38
    v_xor_b32 v12, v76, v38
    v_xor_b32 v13, v80, v38
    v_xor_b32 v14, v84, v38
    v_or3_b32 v10, v11, v12, v13
    v_bitop3_b32 v10, v10, v14, s42 bitop3:0xa8
    v_cmp_ne_u32 vcc, 0, v10
    s_cbranch_vccz L_ok18
    s_sub_u32 s58, s58, 1
    s_cbranch_scc1 L_ok18
    v_and_b32 v10, s42, v11
    v_cmp_ne_u32 vcc, 0, v10
    s_cbranch_vccz L_skip18_0
    buffer_load_dwordx4 v[72:75], v4, s[36:39], s68 offen sc1
L_skip18_0:
    v_and_b32 v10, s42, v12
    v_cmp_ne_u32 vcc, 0, v10
    s_cbranch_vccz L_skip18_1
    buffer_load_dwordx4 v[76:79], v4, s[36:39], s69 offen sc1
L_skip18_1:
    v_and_b32 v10, s42, v13
    v_cmp_ne_u32 vcc, 0, v10
    s_cbranch_vccz L_skip18_2
    buffer_load_dwordx4 v[80:83], v4, s[36:39], s72 offen sc1
L_skip18_2:
    v_and_b32 v10, s42, v14
    v_cmp_ne_u32 vcc, 0, v10
    s_cbranch_vccz L_skip18_3
    buffer_load_dwordx4 v[84:87], v4, s[36:39], s73 offen sc1
L_skip18_3:
    s_branch L_poll18
L_ok18:
    v_xor_b32 v72, v72, v38
    v_xor_b32 v76, v76, v38
    v_xor_b32 v80, v80, v38
    v_xor_b32 v84, v84, v38
    v_pk_add_f32 v[72:73], v[72:73], v[76:77]
    v_pk_add_f32 v[74:75], v[74:75], v[78:79]
    v_pk_add_f32 v[72:73], v[72:73], v[80:81]
    v_pk_add_f32 v[74:75], v[74:75], v[82:83]
    v_pk_add_f32 v[72:73], v[72:73], v[84:85]
    v_pk_add_f32 v[74:75], v[74:75], v[86:87]
    s_nop 1
    v_permlane32_swap_b32 v72, v74
    v_permlane32_swap_b32 v73, v75
    v_add_f32 v72, v72, v74
    v_add_f32 v73, v73, v75
    v_add_f32 v72, v72, v27
    v_add_f32 v73, v73, v26
    v_cvt_pk_bf16_f32 v72, v72, v73
    ds_write_b32 v6, v72
    ds_read_b128 v[92:95], v7 offset:0
    ds_read_b128 v[96:99], v7 offset:64
    ds_read_b128 v[100:103], v7 offset:128
    ds_read_b128 v[104:107], v7 offset:192
    v_lshlrev_b32 v73, 16, v72
    v_and_b32 v72, s67, v72
    v_add_f32 v74, v72, v73
    v_mul_f32 v75, v72, v72
    v_fmac_f32 v75, v73, v73
    s_nop 1
    v_permlane32_swap_b32 v74, v75
    v_add_f32 v74, v74, v75
    s_waitcnt lgkmcnt(3)
    v_mfma_f32_16x16x32_bf16 v[108:111], v[92:95], v[40:43], 0
    v_mfma_f32_16x16x32_bf16 v[112:115], v[92:95], v[44:47], 0
    v_add_f32_dpp v74, v74, v74 row_ror:8 row_mask:0xf bank_mask:0xf
    s_waitcnt lgkmcnt(2)
    v_mfma_f32_16x16x32_bf16 v[108:111], v[96:99], v[48:51], v[108:111]
    v_mfma_f32_16x16x32_bf16 v[112:115], v[96:99], v[52:55], v[112:115]
    v_add_f32_dpp v74, v74, v74 row_ror:4 row_mask:0xf bank_mask:0xf
    s_waitcnt lgkmcnt(1)
    v_mfma_f32_16x16x32_bf16 v[108:111], v[100:103], v[56:59], v[108:111]
    v_mfma_f32_16x16x32_bf16 v[112:115], v[100:103], v[60:63], v[112:115]
    v_add_f32_dpp v74, v74, v74 row_ror:2 row_mask:0xf bank_mask:0xf
    s_waitcnt lgkmcnt(0)
    v_mfma_f32_16x16x32_bf16 v[108:111], v[104:107], v[64:67], v[108:111]
    v_mfma_f32_16x16x32_bf16 v[112:115], v[104:107], v[68:71], v[112:115]
    v_add_f32_dpp v74, v74, v74 row_ror:1 row_mask:0xf bank_mask:0xf
    s_mov_b32 exec_lo, 0x00010001
    s_mov_b32 exec_hi, 0x00010001
    ds_add_f32 v23, v74
    s_mov_b64 exec, 0xffff
    s_nop 2
    ds_write2_b32 v25, v108, v112 offset0:0 offset1:1
    s_mov_b64 exec, -1
    s_waitcnt lgkmcnt(0)
    s_barrier
    ds_read_b64 v[16:17], v24
    ds_read_b64 v[14:15], v22 offset:1024
    ds_read_b64 v[12:13], v22 offset:1536
    ds_read_b64 v[94:95], v22 offset:1664
    ds_read_b64 v[96:97], v22 offset:1792
    ds_read_b64 v[98:99], v22 offset:1920
    s_waitcnt lgkmcnt(5)
    v_mul_f32 v16, v16, v29
    v_fmaak_f32 v17, v17, v29, 0x3727c5ac
    v_fma_f32 v17, -v16, v16, v17
    v_max_f32 v17, 0x3727c5ac, v17
    v_rsq_f32 v17, v17
    s_waitcnt lgkmcnt(0)
    v_pk_add_f32 v[12:13], v[12:13], v[94:95]
    v_pk_add_f32 v[96:97], v[96:97], v[98:99]
    v_pk_add_f32 v[12:13], v[12:13], v[96:97]
    v_mul_f32 v18, 0xbfb8aa3b, v17
    v_fma_f32 v12, -v16, v14, v12
    v_fma_f32 v13, -v16, v15, v13
    v_mul_f32 v12, v12, v18
    v_exp_f32 v12, v12
    v_mul_f32 v13, v13, v17
    v_add_f32 v12, 1.0, v12
    v_rcp_f32 v12, v12
    s_nop 0
    v_mul_f32 v12, v12, v13
    s_nop 1
    v_mov_b32_dpp v13, v12 quad_perm:[1,0,3,2] row_mask:0xf bank_mask:0xf
    v_cvt_pk_bf16_f32 v12, v12, v13
    s_nop 1
    v_dot2c_f32_bf16_dpp v30, v12, v136 row_newbcast:0 row_mask:0xf bank_mask:0xf
    v_dot2c_f32_bf16_dpp v31, v12, v144 row_newbcast:0 row_mask:0xf bank_mask:0xf
    v_dot2c_f32_bf16_dpp v30, v12, v137 row_newbcast:2 row_mask:0xf bank_mask:0xf
    v_dot2c_f32_bf16_dpp v31, v12, v145 row_newbcast:2 row_mask:0xf bank_mask:0xf
    v_dot2c_f32_bf16_dpp v30, v12, v138 row_newbcast:4 row_mask:0xf bank_mask:0xf
    v_dot2c_f32_bf16_dpp v31, v12, v146 row_newbcast:4 row_mask:0xf bank_mask:0xf
    v_dot2c_f32_bf16_dpp v30, v12, v139 row_newbcast:6 row_mask:0xf bank_mask:0xf
    v_dot2c_f32_bf16_dpp v31, v12, v147 row_newbcast:6 row_mask:0xf bank_mask:0xf
    v_dot2c_f32_bf16_dpp v30, v12, v140 row_newbcast:8 row_mask:0xf bank_mask:0xf
    v_dot2c_f32_bf16_dpp v31, v12, v148 row_newbcast:8 row_mask:0xf bank_mask:0xf
    v_dot2c_f32_bf16_dpp v30, v12, v141 row_newbcast:10 row_mask:0xf bank_mask:0xf
    v_dot2c_f32_bf16_dpp v31, v12, v149 row_newbcast:10 row_mask:0xf bank_mask:0xf
    v_dot2c_f32_bf16_dpp v30, v12, v142 row_newbcast:12 row_mask:0xf bank_mask:0xf
    v_dot2c_f32_bf16_dpp v31, v12, v150 row_newbcast:12 row_mask:0xf bank_mask:0xf
    v_dot2c_f32_bf16_dpp v30, v12, v143 row_newbcast:14 row_mask:0xf bank_mask:0xf
    v_dot2c_f32_bf16_dpp v31, v12, v151 row_newbcast:14 row_mask:0xf bank_mask:0xf
    s_nop 1
    v_bfi_b32 v30, s42, v38, v30
    v_bfi_b32 v31, s42, v38, v31
    buffer_store_dwordx2 v[30:31], v21, s[36:39], 0 offen sc1
    s_endpgm
L_exit:
    s_endpgm
.p2align 2
.type L_table,@object
L_table:
    .short 0x400, 0x2204, 0x3201, 0x4005, 0x4009, 0x4802, 0x8806, 0xc80a
    .short 0x408, 0x221c, 0x320d, 0x4011, 0x4015, 0x480e, 0x8812, 0xc816
    .short 0x410, 0x2214, 0x3219, 0x401d, 0x4021, 0x481a, 0x881e, 0xc822
    .short 0x218, 0x100c, 0x1225, 0x2029, 0x2826, 0x682a, 0xa62e, 0xd632
    .short 0x400, 0x2204, 0x322d, 0x4031, 0x4035, 0x4802, 0x8806, 0xc80a
    .short 0x408, 0x221c, 0x3239, 0x403d, 0x4041, 0x480e, 0x8812, 0xc816
    .short 0x410, 0x2214, 0x3245, 0x4049, 0x404d, 0x481a, 0x881e, 0xc822
    .short 0x218, 0x100c, 0x1251, 0x2055, 0x2826, 0x682a, 0xa62e, 0xd632
    .short 0x400, 0x2204, 0x3259, 0x405d, 0x4061, 0x4802, 0x8806, 0xc80a
    .short 0x408, 0x221c, 0x3265, 0x4069, 0x406d, 0x480e, 0x8812, 0xc816
    .short 0x410, 0x2214, 0x3271, 0x4075, 0x4079, 0x481a, 0x881e, 0xc822
    .short 0x218, 0x100c, 0x127d, 0x2081, 0x2826, 0x682a, 0xa62e, 0xd632
    .short 0x400, 0x2204, 0x3285, 0x4089, 0x408d, 0x4802, 0x8806, 0xc80a
    .short 0x408, 0x221c, 0x3291, 0x4095, 0x4099, 0x480e, 0x8812, 0xc816
    .short 0x410, 0x2214, 0x329d, 0x40a1, 0x40a5, 0x481a, 0x881e, 0xc822
    .short 0x218, 0x100c, 0x12a9, 0x20ad, 0x2826, 0x682a, 0xa62e, 0xd632
    .short 0x400, 0x2204, 0x32b1, 0x40b5, 0x40b9, 0x4802, 0x8806, 0xc80a
    .short 0x408, 0x221c, 0x32bd, 0x40c1, 0x40c5, 0x480e, 0x8812, 0xc816
    .short 0x410, 0x2214, 0x32c9, 0x40cd, 0x40d1, 0x481a, 0x881e, 0xc822
    .short 0x218, 0x100c, 0x12d5, 0x20d9, 0x2826, 0x682a, 0xa62e, 0xd632
    .short 0x400, 0x2204, 0x32dd, 0x40e1, 0x40e5, 0x4802, 0x8806, 0xc80a
    .short 0x408, 0x221c, 0x32e9, 0x40ed, 0x40f1, 0x480e, 0x8812, 0xc816
    .short 0x410, 0x2214, 0x32f5, 0x40f9, 0x40fd, 0x481a, 0x881e, 0xc822
    .short 0x218, 0x100c, 0x1301, 0x2105, 0x2826, 0x682a, 0xa62e, 0xd632
    .short 0x400, 0x2204, 0x3309, 0x410d, 0x4111, 0x4802, 0x8806, 0xc80a
    .short 0x408, 0x221c, 0x3315, 0x4119, 0x411d, 0x480e, 0x8812, 0xc816
    .short 0x210, 0x1214, 0x2121, 0x2125, 0x281a, 0x681e, 0xa622, 0xd626
    .short 0x218, 0x100c, 0x1329, 0x212d, 0x282a, 0x682e, 0xa632, 0xd636
    .short 0x400, 0x2204, 0x3331, 0x4135, 0x4139, 0x4802, 0x8806, 0xc80a
    .short 0x408, 0x221c, 0x333d, 0x4141, 0x4145, 0x480e, 0x8812, 0xc816
    .short 0x210, 0x1214, 0x2149, 0x214d, 0x281a, 0x681e, 0xa622, 0xd626
    .short 0x218, 0x100c, 0x1351, 0x2155, 0x282a, 0x682e, 0xa632, 0xd636
.size L_table, 512
L_last:
.section .rodata,"a"
.p2align 6
.amdhsa_kernel sequential_preLN__mha_block_cached__glu_gated_glu__decode_kernel
  .amdhsa_next_free_vgpr 168
  .amdhsa_next_free_sgpr 102
  .amdhsa_accum_offset 168
  .amdhsa_group_segment_fixed_size 0
  .amdhsa_kernarg_size 96
  .amdhsa_user_sgpr_count 2
  .amdhsa_user_sgpr_kernarg_segment_ptr 1
  .amdhsa_system_sgpr_workgroup_id_x 1
  .amdhsa_float_denorm_mode_32 3
.end_amdhsa_kernel
```
